```python
import torch

def _softmax(x, axis=-1):
    return torch.softmax(x, dim=axis)
def _gelu(x):
    return torch.nn.functional.gelu(x, approximate="tanh")
def _silu(x):
    return torch.nn.functional.silu(x)
def _sigmoid(x):
    return torch.sigmoid(x)
def _layernorm(x, axis=-1, eps=1e-5):
    m = x.mean(dim=axis, keepdim=True)
    v = x.var(dim=axis, keepdim=True, unbiased=False)
    return (x - m) / torch.sqrt(v + eps)
def _scatter_add(tgt, idx, src, axis=0):
    return tgt.clone().index_add_(axis, idx, src)
def _segment_sum(src, seg, n):
    out = torch.zeros((n,) + src.shape[1:], dtype=src.dtype)
    return out.index_add_(0, seg, src)
def _pad(x, pw):
    flat = tuple(v for pair in reversed(pw) for v in pair)
    return torch.nn.functional.pad(x, flat)

kernel_name = 'parallel_sum__sliding_local_dilated__mixer_s_mlp__prompt'

def setup_inputs():

    _w = (lambda a: (lambda t: t.to(torch.bfloat16) if t.is_floating_point() else t)(torch.as_tensor(a)))
    def _A_setup():
        B, S, D = 1, 2048, 512
        return {
            "x": _w((lambda *s: torch.randn(*s, dtype=torch.bfloat16) * 0.05)(B, S, D)),
            "wqkv": _w((lambda *s: torch.randn(*s, dtype=torch.bfloat16) * 0.05)(D, 3 * D)),
            "wo": _w((lambda *s: torch.randn(*s, dtype=torch.bfloat16) * 0.05)(D, D)),
        }
    _A_in = _A_setup()

    def _B_setup():
        B, S, D, F = 1, 2048, 512, 1376
        return {
            "x":  _w((lambda *s: torch.randn(*s, dtype=torch.bfloat16) * 0.05)(B, S, D)),
            "w1": _w((lambda *s: torch.randn(*s, dtype=torch.bfloat16) * 0.8)(D, D) * (D ** -0.5)),
            "w2": _w((lambda *s: torch.randn(*s, dtype=torch.bfloat16) * 0.8)(D, D) * (D ** -0.5)),
            "w3": _w((lambda *s: torch.randn(*s, dtype=torch.bfloat16) * 0.8)(D, F) * (D ** -0.5)),
            "w4": _w((lambda *s: torch.randn(*s, dtype=torch.bfloat16) * 0.8)(F, D) * (F ** -0.5)),
        }
    _B_in = _B_setup()

    return {
        "A_x": _A_in["x"],
        "A_wqkv": _A_in["wqkv"],
        "A_wo": _A_in["wo"],
        "B_x": _B_in["x"],
        "B_w1": _B_in["w1"],
        "B_w2": _B_in["w2"],
        "B_w3": _B_in["w3"],
        "B_w4": _B_in["w4"],
    }

def reference(A_x, A_wqkv, A_wo, B_x, B_w1, B_w2, B_w3, B_w4):
    def _A_ref(x, wqkv, wo):
        B, S, D = x.shape
        H = 32; Dh = D // H
        W, dil = 8, 2
        qkv = (lambda x, *d: x.permute(*d))((x @ wqkv).reshape(B, S, 3, H, Dh), 2, 0, 3, 1, 4)
        q, k, v = qkv[0], qkv[1], qkv[2]
        scale = Dh ** -0.5
        pos = torch.arange(S)
        off = torch.arange(W) * dil
        idx = pos[:, None] - off[None, :]
        mask = idx >= 0
        idx_c = torch.where(mask, idx, 0).reshape(-1)
        kg = k[:, :, idx_c, :].reshape(B, H, S, W, Dh)
        vg = v[:, :, idx_c, :].reshape(B, H, S, W, Dh)
        logits = torch.einsum("bhsd,bhswd->bhsw", q, kg) * scale
        logits = torch.where(mask[None, None, :, :], logits, -1e9)
        attn = _softmax(logits, axis=-1)
        o = torch.einsum("bhsw,bhswd->bhsd", attn, vg)
        return (lambda x, *d: x.permute(*d))(o, 0, 2, 1, 3).reshape(B, S, D) @ wo

    def _B_ref(x, w1, w2, w3, w4):
        B, S, D = x.shape
        h = _gelu(_layernorm(x, axis=-1) @ w1)
        c = D // 4
        g0 = _pad(h[:, :, 0*c:1*c], ((0, 0), (1, 0), (0, 0)))[:, :S, :]
        g1 = _pad(h[:, :, 1*c:2*c], ((0, 0), (0, 1), (0, 0)))[:, 1:, :]
        g2 = _pad(h[:, :, 2*c:3*c], ((0, 0), (2, 0), (0, 0)))[:, :S, :]
        g3 = _pad(h[:, :, 3*c:   ], ((0, 0), (0, 2), (0, 0)))[:, 2:, :]
        hs = torch.concatenate([g0, g1, g2, g3], axis=-1) @ w2
        x1 = x + hs
        h2 = _gelu(_layernorm(x1, axis=-1) @ w3) @ w4
        return x1 + h2

    x = A_x
    xn = _layernorm(x, axis=-1)
    return x + _A_ref(xn, A_wqkv, A_wo) + _B_ref(xn, B_w1, B_w2, B_w3, B_w4)
```

```asm
; @launch grid=(256,1,1) block=(512,1,1) lds=163840
.amdgcn_target "amdgcn-amd-amdhsa--gfx950"
.text
.globl parallel_sum__sliding_local_dilated__mixer_s_mlp__prompt_kernel
.p2align 8
.type parallel_sum__sliding_local_dilated__mixer_s_mlp__prompt_kernel,@function
parallel_sum__sliding_local_dilated__mixer_s_mlp__prompt_kernel:
  s_cmp_ge_u32 s2, 256
  s_cbranch_scc1 L_END
  s_load_dwordx16 s[52:67], s[0:1], 0
  s_load_dwordx4 s[68:71], s[0:1], 64
  s_load_dwordx2 s[72:73], s[0:1], 80
  v_and_b32 v1, 63, v0
  v_lshrrev_b32 v4, 6, v0
  v_and_b32 v2, 15, v0
  v_readfirstlane_b32 s48, v4
  v_lshrrev_b32 v3, 4, v1
  s_lshr_b32 s74, s2, 1
  s_and_b32 s74, s74, 3
  s_lshl_b32 s74, s74, 3
  s_lshr_b32 s75, s2, 5
  s_add_u32 s46, s74, s75
  s_and_b32 s74, s2, 1
  s_lshl_b32 s74, s74, 2
  s_lshr_b32 s75, s2, 3
  s_and_b32 s75, s75, 3
  s_add_u32 s47, s74, s75
  s_lshl_b32 s50, s46, 3
  s_add_u32 s50, s50, s47
  s_and_b32 s74, s47, 3
  s_lshl_b32 s74, s74, 1
  s_add_u32 s74, s74, s46
  s_and_b32 s51, s74, 7
  s_cmp_ge_u32 s48, 4
  s_cbranch_scc1 L_LOADER
  s_lshr_b32 s74, s2, 3
  s_lshl_b32 s74, s74, 2
  s_add_u32 s74, s74, s48
  s_cmp_lt_u32 s74, 36
  s_cbranch_scc0 LC_cpf_1
  s_getpc_b64 s[98:99]
L_PC_HERE:
  s_sub_u32 s98, s98, L_PC_HERE-parallel_sum__sliding_local_dilated__mixer_s_mlp__prompt_kernel
  s_subb_u32 s99, s99, 0
  s_lshl_b32 s74, s74, 10
  s_min_u32 s74, s74, L_CODE_END-parallel_sum__sliding_local_dilated__mixer_s_mlp__prompt_kernel-1024
  v_lshlrev_b32 v4, 4, v1
  v_add_u32 v4, s74, v4
  global_load_dword v146, v4, s[98:99]
LC_cpf_1:
  s_setprio 3
  s_and_b32 s44, s48, 1
  s_lshr_b32 s45, s48, 1
  v_lshrrev_b32 v13, 1, v2
  v_xor_b32 v4, v13, v3
  v_lshlrev_b32 v4, 4, v4
  v_lshl_add_u32 v60, v2, 7, v4
  s_lshl_b32 s74, s44, 12
  s_lshl_b32 s75, s45, 11
  s_add_u32 s74, s74, s75
  v_add_u32 v48, s74, v60
  v_xor_b32 v49, 64, v48
  v_xor_b32 v142, 2048, v48
  v_xor_b32 v143, 2048, v49
  v_add_u32 v50, 65536, v48
  v_add_u32 v252, 65536, v142
  v_add_u32 v51, 65536, v49
  v_add_u32 v253, 65536, v143
  v_add_u32 v52, 131072, v48
  v_add_u32 v254, 131072, v142
  v_add_u32 v53, 131072, v49
  v_add_u32 v255, 131072, v143
  v_lshrrev_b32 v14, 2, v2
  v_lshl_add_u32 v6, v3, 3, v14
  v_and_b32 v15, 3, v1
  v_lshlrev_b32 v8, 7, v6
  v_lshl_add_u32 v10, v15, 3, v8
  v_lshrrev_b32 v8, 1, v14
  v_and_b32 v9, 1, v3
  v_lshl_or_b32 v11, v9, 1, v8
  s_lshl_b32 s74, s45, 1
  s_xor_b32 s75, s44, 0
  s_add_u32 s75, s74, s75
  v_xor_b32 v8, s75, v11
  v_lshl_add_u32 v54, v8, 5, v10
  v_add_u32 v56, 65536, v54
  v_add_u32 v58, 131072, v54
  s_xor_b32 s75, s44, 1
  s_add_u32 s75, s74, s75
  v_xor_b32 v8, s75, v11
  v_lshl_add_u32 v55, v8, 5, v10
  v_add_u32 v57, 65536, v55
  v_add_u32 v59, 131072, v55
  v_mov_b32 v28, 1065369472
  v_mov_b32 v29, 1065369472
  v_mov_b32 v30, 1065369472
  v_mov_b32 v31, 1065369472
  v_mov_b32 v92, v60
  v_xor_b32 v93, 64, v60
  v_xor_b32 v4, s48, v11
  v_lshl_add_u32 v4, v4, 5, v10
  v_add_u32 v96, 131072, v4
  v_add_u32 v97, 65536, v4
  v_add_u32 v98, 90112, v4
  v_mov_b32 v148, 0
  v_mov_b32 v149, 0
  v_mov_b32 v150, 0
  v_mov_b32 v151, 0
  v_mov_b32 v152, 0
  v_mov_b32 v153, 0
  v_mov_b32 v154, 0
  v_mov_b32 v155, 0
  v_mov_b32 v156, 0
  v_mov_b32 v157, 0
  v_mov_b32 v158, 0
  v_mov_b32 v159, 0
  v_mov_b32 v160, 0
  v_mov_b32 v161, 0
  v_mov_b32 v162, 0
  v_mov_b32 v163, 0
  v_mov_b32 v164, 0
  v_mov_b32 v165, 0
  v_mov_b32 v166, 0
  v_mov_b32 v167, 0
  v_mov_b32 v172, 0
  v_mov_b32 v173, 0
  v_mov_b32 v174, 0
  v_mov_b32 v175, 0
  v_mov_b32 v64, 0
  v_mov_b32 v65, 0
  v_mov_b32 v66, 0
  v_mov_b32 v67, 0
  s_waitcnt lgkmcnt(0)
  s_waitcnt lgkmcnt(0)
  s_mov_b32 s36, s72
  s_and_b32 s37, s73, 65535
  s_mov_b32 s38, 16777216
  s_mov_b32 s39, 131072
  s_mov_b32 s32, s68
  s_and_b32 s33, s69, 65535
  s_mov_b32 s34, 2097152
  s_mov_b32 s35, 131072
  v_mov_b32 v4, 14745600
  buffer_load_dword v144, v4, s[36:39], 0 offen sc1
  v_lshlrev_b32 v5, 4, v1
  s_mov_b32 s12, s62
  s_and_b32 s13, s63, 65535
  s_mov_b32 s14, 524288
  s_mov_b32 s15, 131072
  s_mul_i32 s74, s50, 2048
  s_mul_i32 s75, s48, 512
  s_add_u32 s74, s74, s75
  buffer_load_dword v146, v5, s[12:15], s74 offen
  s_mov_b32 s24, s64
  s_and_b32 s25, s65, 65535
  s_mov_b32 s26, 1409024
  s_mov_b32 s27, 131072
  s_mov_b32 s20, s56
  s_and_b32 s21, s57, 65535
  s_mov_b32 s22, 524288
  s_mov_b32 s23, 131072
  s_mov_b32 s28, s66
  s_and_b32 s29, s67, 65535
  s_mov_b32 s30, 1409024
  s_mov_b32 s31, 131072
  s_lshr_b32 s74, s54, 7
  s_sub_u32 s74, 3, s74
  s_and_b32 s74, s74, 7
  s_xor_b32 s75, s74, 4
  s_lshr_b32 s75, s75, 2
  s_lshr_b32 s76, s47, 2
  s_cmp_eq_u32 s75, s76
  s_cbranch_scc0 LC_spf_2
  s_cmp_eq_u32 s48, 1
  s_cbranch_scc0 LC_spf_2
  s_lshr_b32 s76, s2, 3
  s_cmp_lt_u32 s76, 24
  s_cbranch_scc0 LC_spf_2
  s_mov_b32 s12, s54
  s_and_b32 s13, s55, 65535
  s_mov_b32 s14, 1572864
  s_mov_b32 s15, 131072
  s_and_b32 s75, s76, 7
  s_lshl_b32 s75, s75, 6
  v_add_u32 v5, s75, v1
  v_mul_u32_u24 v5, 3072, v5
  s_lshr_b32 s76, s76, 3
  s_lshl_b32 s76, s76, 10
  s_lshl_b32 s74, s74, 7
  s_add_u32 s74, s74, s76
  buffer_load_dword v146, v5, s[12:15], s74 offen
LC_spf_2:
  s_lshr_b32 s90, s46, 1
  s_lshr_b32 s74, s47, 2
  s_lshl_b32 s74, s74, 3
  s_and_b32 s75, s46, 1
  s_lshl_b32 s75, s75, 2
  s_or_b32 s74, s74, s75
  s_and_b32 s75, s47, 3
  s_or_b32 s91, s74, s75
  s_mov_b32 s62, 4718592
  s_mov_b32 s63, 2359296
  s_mov_b32 s64, 7077888
  s_lshl_b32 s67, s50, 7
  s_lshl_b32 s74, s48, 2
  s_add_u32 s67, s67, s74
  s_add_u32 s67, s67, 14680064
  s_mov_b32 s82, 3222493025
  s_mov_b32 s83, 3222493025
  s_mov_b32 s84, 3184710632
  s_mov_b32 s85, 3184710632
  s_mov_b32 s80, 1052289595
  s_mov_b32 s81, 1052289595
  v_mov_b32 v62, s82
  v_mov_b32 v63, s82
  s_lshl_b32 s74, s46, 6
  s_lshl_b32 s75, s44, 5
  s_add_u32 s74, s74, s75
  s_lshl_b32 s75, s45, 4
  s_add_u32 s74, s74, s75
  v_add_u32 v4, s74, v2
  v_lshlrev_b32 v4, 10, v4
  v_lshrrev_b32 v12, 1, v3
  v_xor_b32 v8, s44, v9
  v_lshlrev_b32 v8, 5, v8
  v_lshl_add_u32 v8, v12, 4, v8
  s_lshl_b32 s74, s47, 7
  s_lshl_b32 s75, s45, 6
  s_add_u32 s74, s74, s75
  v_add3_u32 v61, v4, v8, s74
  v_xor_b32 v141, 16384, v61
  v_lshrrev_b32 v4, 10, v61
  v_mul_u32_u24 v4, 1152, v4
  v_and_b32 v5, 1023, v61
  v_add_u32 v94, v4, v5
  v_lshrrev_b32 v4, 10, v141
  v_mul_u32_u24 v4, 1152, v4
  v_and_b32 v5, 1023, v141
  v_add_u32 v95, v4, v5
  s_sub_u32 s74, s47, s51
  s_and_b32 s74, s74, 7
  s_lshl_b32 s74, s74, 13
  s_lshl_b32 s75, s44, 12
  s_add_u32 s74, s74, s75
  s_lshl_b32 s75, s45, 11
  s_add_u32 s74, s74, s75
  v_lshlrev_b32 v6, 3, v9
  v_lshl_add_u32 v6, v2, 7, v6
  v_add_u32 v4, s74, v6
  s_lshl_b32 s75, s45, 2
  v_add_u32 v8, s75, v12
  s_xor_b32 s75, s44, 0
  s_lshl_b32 s75, s75, 1
  v_add_u32 v5, s75, v8
  v_xor_b32 v5, v5, v13
  v_lshl_add_u32 v101, v5, 4, v4
  v_xor_b32 v103, 2048, v101
  s_xor_b32 s75, s44, 1
  s_lshl_b32 s75, s75, 1
  v_add_u32 v5, s75, v8
  v_xor_b32 v5, v5, v13
  v_lshl_add_u32 v102, v5, 4, v4
  v_xor_b32 v104, 2048, v102
  s_lshl_b32 s74, s44, 7
  s_lshl_b32 s75, s45, 6
  s_add_u32 s74, s74, s75
  s_add_u32 s74, s74, 155648
  v_lshlrev_b32 v4, 2, v2
  v_add_u32 v105, s74, v4
  v_xor_b32 v99, 64, v105
  v_add_u32 v106, 155648, v4
  v_lshlrev_b32 v5, 4, v3
  v_add_u32 v107, 155648, v5
  s_lshl_b32 s74, s45, 7
  s_lshl_b32 s75, s44, 6
  s_add_u32 s74, s74, s75
  s_add_u32 s74, s74, 156672
  v_add_u32 v100, s74, v5
  v_xor_b32 v246, 64, v100
  s_lshl_b32 s74, s44, 8
  s_add_u32 s74, s74, 98304
  v_add_u32 v134, s74, v4
  v_lshl_add_u32 v5, v14, 4, v2
  v_lshlrev_b32 v108, 2, v5
  s_lshl_b32 s74, s50, 12
  s_lshl_b32 s75, s48, 10
  s_add_u32 s74, s74, s75
  s_add_u32 s74, s74, 13107200
  v_lshlrev_b32 v5, 3, v1
  v_add_u32 v109, s74, v5
  s_sub_u32 s74, s74, 32768
  s_cmp_eq_u32 s46, 0
  s_cselect_b32 s74, 2130706432, s74
  v_add_u32 v110, s74, v5
  s_sub_u32 s74, s67, 1024
  s_cmp_eq_u32 s46, 0
  s_cselect_b32 s74, s67, s74
  v_mov_b32 v111, s74
  s_lshl_b32 s74, s50, 10
  s_lshl_b32 s75, s45, 9
  s_add_u32 s74, s74, s75
  s_lshl_b32 s75, s44, 8
  s_add_u32 s74, s74, s75
  s_add_u32 s74, s74, 12845056
  v_xor_b32 v4, s45, v3
  v_and_b32 v4, 1, v4
  v_lshl_add_u32 v4, v4, 4, v2
  v_lshlrev_b32 v4, 3, v4
  v_add_u32 v112, s74, v4
  s_lshl_b32 s75, s48, 1
  v_add_u32 v4, s75, v12
  v_and_b32 v5, 7, v2
  v_xor_b32 v4, v4, v5
  v_lshl_add_u32 v4, v4, 4, v6
  v_add_u32 v113, 131072, v4
  s_cmp_eq_u32 s46, 0
  s_cselect_b32 s74, 64, 0
  v_add_u32 v8, 2, v2
  v_add_u32 v7, s74, v8
  v_mov_b32 v140, 4286578688
  v_mov_b32 v145, 0
  v_lshl_add_u32 v4, v3, 2, 0
  v_xor_b32 v5, v4, v2
  v_and_b32 v5, 1, v5
  v_cmp_eq_u32 s[72:73], 0, v5
  v_cmp_ge_u32 vcc, v4, v8
  s_nop 3
  s_and_b64 vcc, vcc, s[72:73]
  v_cndmask_b32 v114, v140, v145, vcc
  v_cmp_ge_u32 vcc, v4, v7
  s_nop 3
  s_and_b64 vcc, vcc, s[72:73]
  v_cndmask_b32 v122, v140, v145, vcc
  v_cmp_le_u32 vcc, v4, v2
  s_nop 3
  s_and_b64 vcc, vcc, s[72:73]
  v_cndmask_b32 v118, v140, v145, vcc
  v_lshl_add_u32 v4, v3, 2, 1
  v_xor_b32 v5, v4, v2
  v_and_b32 v5, 1, v5
  v_cmp_eq_u32 s[72:73], 0, v5
  v_cmp_ge_u32 vcc, v4, v8
  s_nop 3
  s_and_b64 vcc, vcc, s[72:73]
  v_cndmask_b32 v115, v140, v145, vcc
  v_cmp_ge_u32 vcc, v4, v7
  s_nop 3
  s_and_b64 vcc, vcc, s[72:73]
  v_cndmask_b32 v123, v140, v145, vcc
  v_cmp_le_u32 vcc, v4, v2
  s_nop 3
  s_and_b64 vcc, vcc, s[72:73]
  v_cndmask_b32 v119, v140, v145, vcc
  v_lshl_add_u32 v4, v3, 2, 2
  v_xor_b32 v5, v4, v2
  v_and_b32 v5, 1, v5
  v_cmp_eq_u32 s[72:73], 0, v5
  v_cmp_ge_u32 vcc, v4, v8
  s_nop 3
  s_and_b64 vcc, vcc, s[72:73]
  v_cndmask_b32 v116, v140, v145, vcc
  v_cmp_ge_u32 vcc, v4, v7
  s_nop 3
  s_and_b64 vcc, vcc, s[72:73]
  v_cndmask_b32 v124, v140, v145, vcc
  v_cmp_le_u32 vcc, v4, v2
  s_nop 3
  s_and_b64 vcc, vcc, s[72:73]
  v_cndmask_b32 v120, v140, v145, vcc
  v_lshl_add_u32 v4, v3, 2, 3
  v_xor_b32 v5, v4, v2
  v_and_b32 v5, 1, v5
  v_cmp_eq_u32 s[72:73], 0, v5
  v_cmp_ge_u32 vcc, v4, v8
  s_nop 3
  s_and_b64 vcc, vcc, s[72:73]
  v_cndmask_b32 v117, v140, v145, vcc
  v_cmp_ge_u32 vcc, v4, v7
  s_nop 3
  s_and_b64 vcc, vcc, s[72:73]
  v_cndmask_b32 v125, v140, v145, vcc
  v_cmp_le_u32 vcc, v4, v2
  s_nop 3
  s_and_b64 vcc, vcc, s[72:73]
  v_cndmask_b32 v121, v140, v145, vcc
  s_lshl_b32 s74, s44, 13
  s_add_u32 s74, s74, 98304
  v_add_u32 v126, s74, v60
  v_xor_b32 v127, 64, v126
  v_lshl_add_u32 v4, v3, 3, v14
  v_mul_u32_u24 v4, 192, v4
  v_lshl_add_u32 v4, v15, 3, v4
  s_mul_i32 s74, s45, 3
  s_add_u32 s75, s74, 0
  v_xor_b32 v8, s75, v9
  v_lshl_add_u32 v128, v8, 5, v4
  v_add_u32 v129, 49152, v128
  s_add_u32 s75, s74, 1
  v_xor_b32 v8, s75, v9
  v_lshl_add_u32 v130, v8, 5, v4
  v_add_u32 v131, 49152, v130
  s_add_u32 s75, s74, 2
  v_xor_b32 v8, s75, v9
  v_lshl_add_u32 v132, v8, 5, v4
  v_add_u32 v133, 49152, v132
  s_lshl_b32 s74, s44, 6
  v_add_u32 v4, s74, v2
  v_mul_u32_u24 v4, 208, v4
  v_lshl_add_u32 v4, v3, 3, v4
  s_mul_i32 s74, s45, 96
  v_add_u32 v135, s74, v4
  s_lshl_b32 s78, s46, 3
  s_sub_u32 s78, s78, 8
  v_add_u32 v4, s78, v1
  v_cmp_gt_u32 vcc, 256, v4
  v_cmp_gt_u32 s[72:73], 24, v1
  s_nop 3
  s_and_b64 vcc, vcc, s[72:73]
  v_mov_b32 v5, s50
  v_cndmask_b32 v4, v5, v4, vcc
  v_lshlrev_b32 v4, 7, v4
  v_add_u32 v136, 14680064, v4
  s_lshl_b32 s78, s90, 4
  v_add_u32 v4, s78, v1
  v_cmp_gt_u32 vcc, 256, v4
  v_cmp_gt_u32 s[72:73], 16, v1
  s_nop 3
  s_and_b64 vcc, vcc, s[72:73]
  v_mov_b32 v5, s50
  v_cndmask_b32 v4, v5, v4, vcc
  v_lshlrev_b32 v4, 7, v4
  v_add_u32 v137, 14680064, v4
  v_add_u32 v138, 16, v137
  v_and_b32 v4, 3, v2
  v_cmp_eq_u32 s[52:53], 1, v4
  v_cmp_eq_u32 s[54:55], 2, v4
  v_cmp_eq_u32 s[56:57], 3, v4
  v_cmp_eq_u32 s[58:59], 0, v3
  v_cmp_eq_u32 s[68:69], v14, v3
  v_cmp_eq_u32 s[70:71], 0, v2
  v_cmp_gt_u32 s[60:61], 32, v1
  s_barrier
  ds_read_b128 v[180:183], v48 offset:0
  ds_read_b64_tr_b16 v[188:189], v56 offset:0
  ds_read_b64_tr_b16 v[190:191], v56 offset:512
  ds_read_b128 v[184:187], v142 offset:0
  ds_read_b64_tr_b16 v[192:193], v57 offset:0
  ds_read_b64_tr_b16 v[194:195], v57 offset:512
  ds_read_b128 v[196:199], v49 offset:0
  ds_read_b64_tr_b16 v[204:205], v56 offset:4096
  ds_read_b64_tr_b16 v[206:207], v56 offset:4608
  ds_read_b128 v[200:203], v143 offset:0
  ds_read_b64_tr_b16 v[208:209], v57 offset:4096
  ds_read_b64_tr_b16 v[210:211], v57 offset:4608
  s_waitcnt lgkmcnt(0)
  s_barrier
  v_mfma_f32_16x16x32_bf16 v[148:151], v[188:191], v[180:183], v[148:151]
  ds_read_b128 v[212:215], v48 offset:8192
  ds_read_b64_tr_b16 v[220:221], v56 offset:8192
  ds_read_b64_tr_b16 v[222:223], v56 offset:8704
  v_mfma_f32_16x16x32_bf16 v[156:159], v[188:191], v[184:187], v[156:159]
  ds_read_b128 v[216:219], v142 offset:8192
  ds_read_b64_tr_b16 v[224:225], v57 offset:8192
  ds_read_b64_tr_b16 v[226:227], v57 offset:8704
  v_mfma_f32_16x16x32_bf16 v[152:155], v[192:195], v[180:183], v[152:155]
  ds_read_b128 v[228:231], v49 offset:8192
  ds_read_b64_tr_b16 v[236:237], v56 offset:12288
  ds_read_b64_tr_b16 v[238:239], v56 offset:12800
  v_mfma_f32_16x16x32_bf16 v[160:163], v[192:195], v[184:187], v[160:163]
  ds_read_b128 v[232:235], v143 offset:8192
  ds_read_b64_tr_b16 v[240:241], v57 offset:12288
  ds_read_b64_tr_b16 v[242:243], v57 offset:12800
  v_mfma_f32_16x16x32_bf16 v[164:167], v[28:31], v[180:183], v[164:167]
  v_mfma_f32_16x16x32_bf16 v[172:175], v[180:183], v[180:183], v[172:175]
  v_mfma_f32_16x16x32_bf16 v[64:67], v[188:191], v[28:31], v[64:67]
  v_mfma_f32_16x16x32_bf16 v[148:151], v[204:207], v[196:199], v[148:151]
  v_mfma_f32_16x16x32_bf16 v[156:159], v[204:207], v[200:203], v[156:159]
  v_mfma_f32_16x16x32_bf16 v[152:155], v[208:211], v[196:199], v[152:155]
  v_mfma_f32_16x16x32_bf16 v[160:163], v[208:211], v[200:203], v[160:163]
  v_mfma_f32_16x16x32_bf16 v[164:167], v[28:31], v[196:199], v[164:167]
  v_mfma_f32_16x16x32_bf16 v[172:175], v[196:199], v[196:199], v[172:175]
  v_mfma_f32_16x16x32_bf16 v[64:67], v[204:207], v[28:31], v[64:67]
  s_waitcnt lgkmcnt(0)
  s_barrier
  v_mfma_f32_16x16x32_bf16 v[148:151], v[220:223], v[212:215], v[148:151]
  ds_read_b128 v[180:183], v48 offset:16384
  ds_read_b64_tr_b16 v[188:189], v56 offset:16384
  ds_read_b64_tr_b16 v[190:191], v56 offset:16896
  v_mfma_f32_16x16x32_bf16 v[156:159], v[220:223], v[216:219], v[156:159]
  ds_read_b128 v[184:187], v142 offset:16384
  ds_read_b64_tr_b16 v[192:193], v57 offset:16384
  ds_read_b64_tr_b16 v[194:195], v57 offset:16896
  v_mfma_f32_16x16x32_bf16 v[152:155], v[224:227], v[212:215], v[152:155]
  ds_read_b128 v[196:199], v49 offset:16384
  ds_read_b64_tr_b16 v[204:205], v56 offset:20480
  ds_read_b64_tr_b16 v[206:207], v56 offset:20992
  v_mfma_f32_16x16x32_bf16 v[160:163], v[224:227], v[216:219], v[160:163]
  ds_read_b128 v[200:203], v143 offset:16384
  ds_read_b64_tr_b16 v[208:209], v57 offset:20480
  ds_read_b64_tr_b16 v[210:211], v57 offset:20992
  v_mfma_f32_16x16x32_bf16 v[164:167], v[28:31], v[212:215], v[164:167]
  v_mfma_f32_16x16x32_bf16 v[172:175], v[212:215], v[212:215], v[172:175]
  v_mfma_f32_16x16x32_bf16 v[64:67], v[220:223], v[28:31], v[64:67]
  v_mfma_f32_16x16x32_bf16 v[148:151], v[236:239], v[228:231], v[148:151]
  v_mfma_f32_16x16x32_bf16 v[156:159], v[236:239], v[232:235], v[156:159]
  v_mfma_f32_16x16x32_bf16 v[152:155], v[240:243], v[228:231], v[152:155]
  v_mfma_f32_16x16x32_bf16 v[160:163], v[240:243], v[232:235], v[160:163]
  v_mfma_f32_16x16x32_bf16 v[164:167], v[28:31], v[228:231], v[164:167]
  v_mfma_f32_16x16x32_bf16 v[172:175], v[228:231], v[228:231], v[172:175]
  v_mfma_f32_16x16x32_bf16 v[64:67], v[236:239], v[28:31], v[64:67]
  s_waitcnt lgkmcnt(9)
  v_mfma_f32_16x16x32_bf16 v[148:151], v[188:191], v[180:183], v[148:151]
  ds_read_b128 v[212:215], v48 offset:24576
  ds_read_b64_tr_b16 v[220:221], v56 offset:24576
  ds_read_b64_tr_b16 v[222:223], v56 offset:25088
  s_waitcnt lgkmcnt(11)
  v_mfma_f32_16x16x32_bf16 v[156:159], v[188:191], v[184:187], v[156:159]
  ds_read_b128 v[216:219], v142 offset:24576
  ds_read_b64_tr_b16 v[224:225], v57 offset:24576
  ds_read_b64_tr_b16 v[226:227], v57 offset:25088
  s_waitcnt lgkmcnt(12)
  v_mfma_f32_16x16x32_bf16 v[152:155], v[192:195], v[180:183], v[152:155]
  ds_read_b128 v[228:231], v49 offset:24576
  ds_read_b64_tr_b16 v[236:237], v56 offset:28672
  ds_read_b64_tr_b16 v[238:239], v56 offset:29184
  v_mfma_f32_16x16x32_bf16 v[160:163], v[192:195], v[184:187], v[160:163]
  ds_read_b128 v[232:235], v143 offset:24576
  ds_read_b64_tr_b16 v[240:241], v57 offset:28672
  ds_read_b64_tr_b16 v[242:243], v57 offset:29184
  v_mfma_f32_16x16x32_bf16 v[164:167], v[28:31], v[180:183], v[164:167]
  v_mfma_f32_16x16x32_bf16 v[172:175], v[180:183], v[180:183], v[172:175]
  v_mfma_f32_16x16x32_bf16 v[64:67], v[188:191], v[28:31], v[64:67]
  s_waitcnt lgkmcnt(15)
  v_mfma_f32_16x16x32_bf16 v[148:151], v[204:207], v[196:199], v[148:151]
  s_waitcnt lgkmcnt(14)
  v_mfma_f32_16x16x32_bf16 v[156:159], v[204:207], v[200:203], v[156:159]
  s_waitcnt lgkmcnt(12)
  v_mfma_f32_16x16x32_bf16 v[152:155], v[208:211], v[196:199], v[152:155]
  v_mfma_f32_16x16x32_bf16 v[160:163], v[208:211], v[200:203], v[160:163]
  v_mfma_f32_16x16x32_bf16 v[164:167], v[28:31], v[196:199], v[164:167]
  v_mfma_f32_16x16x32_bf16 v[172:175], v[196:199], v[196:199], v[172:175]
  v_mfma_f32_16x16x32_bf16 v[64:67], v[204:207], v[28:31], v[64:67]
  s_waitcnt lgkmcnt(0)
  s_barrier
  v_mfma_f32_16x16x32_bf16 v[148:151], v[220:223], v[212:215], v[148:151]
  ds_read_b128 v[180:183], v48 offset:32768
  ds_read_b64_tr_b16 v[188:189], v56 offset:32768
  ds_read_b64_tr_b16 v[190:191], v56 offset:33280
  v_mfma_f32_16x16x32_bf16 v[156:159], v[220:223], v[216:219], v[156:159]
  ds_read_b128 v[184:187], v142 offset:32768
  ds_read_b64_tr_b16 v[192:193], v57 offset:32768
  ds_read_b64_tr_b16 v[194:195], v57 offset:33280
  v_mfma_f32_16x16x32_bf16 v[152:155], v[224:227], v[212:215], v[152:155]
  ds_read_b128 v[196:199], v49 offset:32768
  ds_read_b64_tr_b16 v[204:205], v56 offset:36864
  ds_read_b64_tr_b16 v[206:207], v56 offset:37376
  v_mfma_f32_16x16x32_bf16 v[160:163], v[224:227], v[216:219], v[160:163]
  ds_read_b128 v[200:203], v143 offset:32768
  ds_read_b64_tr_b16 v[208:209], v57 offset:36864
  ds_read_b64_tr_b16 v[210:211], v57 offset:37376
  v_mfma_f32_16x16x32_bf16 v[164:167], v[28:31], v[212:215], v[164:167]
  v_mfma_f32_16x16x32_bf16 v[172:175], v[212:215], v[212:215], v[172:175]
  v_mfma_f32_16x16x32_bf16 v[64:67], v[220:223], v[28:31], v[64:67]
  v_mfma_f32_16x16x32_bf16 v[148:151], v[236:239], v[228:231], v[148:151]
  v_mfma_f32_16x16x32_bf16 v[156:159], v[236:239], v[232:235], v[156:159]
  v_mfma_f32_16x16x32_bf16 v[152:155], v[240:243], v[228:231], v[152:155]
  v_mfma_f32_16x16x32_bf16 v[160:163], v[240:243], v[232:235], v[160:163]
  v_mfma_f32_16x16x32_bf16 v[164:167], v[28:31], v[228:231], v[164:167]
  v_mfma_f32_16x16x32_bf16 v[172:175], v[228:231], v[228:231], v[172:175]
  v_mfma_f32_16x16x32_bf16 v[64:67], v[236:239], v[28:31], v[64:67]
  s_waitcnt lgkmcnt(9)
  v_mfma_f32_16x16x32_bf16 v[148:151], v[188:191], v[180:183], v[148:151]
  ds_read_b128 v[212:215], v48 offset:40960
  ds_read_b64_tr_b16 v[220:221], v56 offset:40960
  ds_read_b64_tr_b16 v[222:223], v56 offset:41472
  s_waitcnt lgkmcnt(11)
  v_mfma_f32_16x16x32_bf16 v[156:159], v[188:191], v[184:187], v[156:159]
  ds_read_b128 v[216:219], v142 offset:40960
  ds_read_b64_tr_b16 v[224:225], v57 offset:40960
  ds_read_b64_tr_b16 v[226:227], v57 offset:41472
  s_waitcnt lgkmcnt(12)
  v_mfma_f32_16x16x32_bf16 v[152:155], v[192:195], v[180:183], v[152:155]
  ds_read_b128 v[228:231], v49 offset:40960
  ds_read_b64_tr_b16 v[236:237], v56 offset:45056
  ds_read_b64_tr_b16 v[238:239], v56 offset:45568
  v_mfma_f32_16x16x32_bf16 v[160:163], v[192:195], v[184:187], v[160:163]
  ds_read_b128 v[232:235], v143 offset:40960
  ds_read_b64_tr_b16 v[240:241], v57 offset:45056
  ds_read_b64_tr_b16 v[242:243], v57 offset:45568
  v_mfma_f32_16x16x32_bf16 v[164:167], v[28:31], v[180:183], v[164:167]
  v_mfma_f32_16x16x32_bf16 v[172:175], v[180:183], v[180:183], v[172:175]
  v_mfma_f32_16x16x32_bf16 v[64:67], v[188:191], v[28:31], v[64:67]
  s_waitcnt lgkmcnt(15)
  v_mfma_f32_16x16x32_bf16 v[148:151], v[204:207], v[196:199], v[148:151]
  s_waitcnt lgkmcnt(14)
  v_mfma_f32_16x16x32_bf16 v[156:159], v[204:207], v[200:203], v[156:159]
  s_waitcnt lgkmcnt(12)
  v_mfma_f32_16x16x32_bf16 v[152:155], v[208:211], v[196:199], v[152:155]
  v_mfma_f32_16x16x32_bf16 v[160:163], v[208:211], v[200:203], v[160:163]
  v_mfma_f32_16x16x32_bf16 v[164:167], v[28:31], v[196:199], v[164:167]
  v_mfma_f32_16x16x32_bf16 v[172:175], v[196:199], v[196:199], v[172:175]
  v_mfma_f32_16x16x32_bf16 v[64:67], v[204:207], v[28:31], v[64:67]
  s_waitcnt lgkmcnt(0)
  s_barrier
  v_mfma_f32_16x16x32_bf16 v[148:151], v[220:223], v[212:215], v[148:151]
  ds_read_b128 v[180:183], v48 offset:49152
  ds_read_b64_tr_b16 v[188:189], v56 offset:49152
  ds_read_b64_tr_b16 v[190:191], v56 offset:49664
  v_mfma_f32_16x16x32_bf16 v[156:159], v[220:223], v[216:219], v[156:159]
  ds_read_b128 v[184:187], v142 offset:49152
  ds_read_b64_tr_b16 v[192:193], v57 offset:49152
  ds_read_b64_tr_b16 v[194:195], v57 offset:49664
  v_mfma_f32_16x16x32_bf16 v[152:155], v[224:227], v[212:215], v[152:155]
  ds_read_b128 v[196:199], v49 offset:49152
  ds_read_b64_tr_b16 v[204:205], v56 offset:53248
  ds_read_b64_tr_b16 v[206:207], v56 offset:53760
  v_mfma_f32_16x16x32_bf16 v[160:163], v[224:227], v[216:219], v[160:163]
  ds_read_b128 v[200:203], v143 offset:49152
  ds_read_b64_tr_b16 v[208:209], v57 offset:53248
  ds_read_b64_tr_b16 v[210:211], v57 offset:53760
  v_mfma_f32_16x16x32_bf16 v[164:167], v[28:31], v[212:215], v[164:167]
  v_mfma_f32_16x16x32_bf16 v[172:175], v[212:215], v[212:215], v[172:175]
  v_mfma_f32_16x16x32_bf16 v[64:67], v[220:223], v[28:31], v[64:67]
  v_mfma_f32_16x16x32_bf16 v[148:151], v[236:239], v[228:231], v[148:151]
  v_mfma_f32_16x16x32_bf16 v[156:159], v[236:239], v[232:235], v[156:159]
  v_mfma_f32_16x16x32_bf16 v[152:155], v[240:243], v[228:231], v[152:155]
  v_mfma_f32_16x16x32_bf16 v[160:163], v[240:243], v[232:235], v[160:163]
  v_mfma_f32_16x16x32_bf16 v[164:167], v[28:31], v[228:231], v[164:167]
  v_mfma_f32_16x16x32_bf16 v[172:175], v[228:231], v[228:231], v[172:175]
  v_mfma_f32_16x16x32_bf16 v[64:67], v[236:239], v[28:31], v[64:67]
  s_waitcnt lgkmcnt(9)
  v_mfma_f32_16x16x32_bf16 v[148:151], v[188:191], v[180:183], v[148:151]
  ds_read_b128 v[212:215], v48 offset:57344
  ds_read_b64_tr_b16 v[220:221], v56 offset:57344
  ds_read_b64_tr_b16 v[222:223], v56 offset:57856
  s_waitcnt lgkmcnt(11)
  v_mfma_f32_16x16x32_bf16 v[156:159], v[188:191], v[184:187], v[156:159]
  ds_read_b128 v[216:219], v142 offset:57344
  ds_read_b64_tr_b16 v[224:225], v57 offset:57344
  ds_read_b64_tr_b16 v[226:227], v57 offset:57856
  s_waitcnt lgkmcnt(12)
  v_mfma_f32_16x16x32_bf16 v[152:155], v[192:195], v[180:183], v[152:155]
  ds_read_b128 v[228:231], v49 offset:57344
  ds_read_b64_tr_b16 v[236:237], v56 offset:61440
  ds_read_b64_tr_b16 v[238:239], v56 offset:61952
  v_mfma_f32_16x16x32_bf16 v[160:163], v[192:195], v[184:187], v[160:163]
  ds_read_b128 v[232:235], v143 offset:57344
  ds_read_b64_tr_b16 v[240:241], v57 offset:61440
  ds_read_b64_tr_b16 v[242:243], v57 offset:61952
  v_mfma_f32_16x16x32_bf16 v[164:167], v[28:31], v[180:183], v[164:167]
  v_mfma_f32_16x16x32_bf16 v[172:175], v[180:183], v[180:183], v[172:175]
  v_mfma_f32_16x16x32_bf16 v[64:67], v[188:191], v[28:31], v[64:67]
  s_waitcnt lgkmcnt(15)
  v_mfma_f32_16x16x32_bf16 v[148:151], v[204:207], v[196:199], v[148:151]
  s_waitcnt lgkmcnt(14)
  v_mfma_f32_16x16x32_bf16 v[156:159], v[204:207], v[200:203], v[156:159]
  s_waitcnt lgkmcnt(12)
  v_mfma_f32_16x16x32_bf16 v[152:155], v[208:211], v[196:199], v[152:155]
  v_mfma_f32_16x16x32_bf16 v[160:163], v[208:211], v[200:203], v[160:163]
  v_mfma_f32_16x16x32_bf16 v[164:167], v[28:31], v[196:199], v[164:167]
  v_mfma_f32_16x16x32_bf16 v[172:175], v[196:199], v[196:199], v[172:175]
  v_mfma_f32_16x16x32_bf16 v[64:67], v[204:207], v[28:31], v[64:67]
  s_waitcnt lgkmcnt(9)
  v_mfma_f32_16x16x32_bf16 v[148:151], v[220:223], v[212:215], v[148:151]
  s_waitcnt lgkmcnt(8)
  v_mfma_f32_16x16x32_bf16 v[156:159], v[220:223], v[216:219], v[156:159]
  s_waitcnt lgkmcnt(6)
  v_mfma_f32_16x16x32_bf16 v[152:155], v[224:227], v[212:215], v[152:155]
  v_mfma_f32_16x16x32_bf16 v[160:163], v[224:227], v[216:219], v[160:163]
  v_mfma_f32_16x16x32_bf16 v[164:167], v[28:31], v[212:215], v[164:167]
  v_mfma_f32_16x16x32_bf16 v[172:175], v[212:215], v[212:215], v[172:175]
  v_mfma_f32_16x16x32_bf16 v[64:67], v[220:223], v[28:31], v[64:67]
  s_waitcnt lgkmcnt(3)
  v_mfma_f32_16x16x32_bf16 v[148:151], v[236:239], v[228:231], v[148:151]
  s_waitcnt lgkmcnt(2)
  v_mfma_f32_16x16x32_bf16 v[156:159], v[236:239], v[232:235], v[156:159]
  s_waitcnt lgkmcnt(0)
  v_mfma_f32_16x16x32_bf16 v[152:155], v[240:243], v[228:231], v[152:155]
  v_mfma_f32_16x16x32_bf16 v[160:163], v[240:243], v[232:235], v[160:163]
  v_mfma_f32_16x16x32_bf16 v[164:167], v[28:31], v[228:231], v[164:167]
  v_mfma_f32_16x16x32_bf16 v[172:175], v[228:231], v[228:231], v[172:175]
  v_mfma_f32_16x16x32_bf16 v[64:67], v[236:239], v[28:31], v[64:67]
  ds_read_b64 v[20:21], v101
  ds_read_b64 v[22:23], v102
  ds_read_b64 v[24:25], v103
  ds_read_b64 v[26:27], v104
  s_nop 2
  v_cndmask_b32 v4, v172, v173, s[52:53]
  v_cndmask_b32 v4, v4, v174, s[54:55]
  v_cndmask_b32 v4, v4, v175, s[56:57]
  ds_bpermute_b32 v6, v108, v4
  s_mov_b64 exec, s[70:71]
  ds_write_b128 v100, v[64:67]
  s_mov_b64 exec, -1
  v_mul_f32 v180, 989855744, v164
  s_waitcnt lgkmcnt(1)
  v_mul_f32 v6, 989855744, v6
  v_fma_f32 v6, -v180, v180, v6
  v_max_f32 v6, 0, v6
  v_add_f32 v164, 925353388, v6
  v_rsq_f32 v184, v164
  s_nop 0
  v_mul_f32 v8, v184, v184
  v_mov_b32 v10, 925353388
  v_fma_f32 v8, v6, v8, v10
  v_rsq_f32 v8, v8
  s_nop 0
  v_mul_f32 v188, v184, v8
  s_mov_b64 exec, s[58:59]
  ds_write_b32 v105, v180
  ds_write_b32 v105, v184 offset:256
  ds_write_b32 v105, v188 offset:512
  s_mov_b64 exec, -1
  s_waitcnt lgkmcnt(0)
  s_barrier
  ds_read_b32 v182, v99
  ds_read_b32 v186, v99 offset:256
  ds_read_b32 v190, v99 offset:512
  ds_read_b128 v[68:71], v246
  v_mov_b32 v16, v180
  v_mov_b32 v18, v184
  s_waitcnt lgkmcnt(3)
  v_mov_b32 v17, v182
  s_waitcnt lgkmcnt(2)
  v_mov_b32 v19, v186
  v_pk_fma_f32 v[148:149], v[64:65], v[180:181], v[148:149] op_sel_hi:[1,0,1] neg_lo:[0,1,0] neg_hi:[0,1,0]
  v_pk_fma_f32 v[150:151], v[66:67], v[180:181], v[150:151] op_sel_hi:[1,0,1] neg_lo:[0,1,0] neg_hi:[0,1,0]
  s_waitcnt lgkmcnt(0)
  v_pk_fma_f32 v[152:153], v[68:69], v[180:181], v[152:153] op_sel_hi:[1,0,1] neg_lo:[0,1,0] neg_hi:[0,1,0]
  v_pk_fma_f32 v[154:155], v[70:71], v[180:181], v[154:155] op_sel_hi:[1,0,1] neg_lo:[0,1,0] neg_hi:[0,1,0]
  v_pk_fma_f32 v[156:157], v[64:65], v[182:183], v[156:157] op_sel_hi:[1,0,1] neg_lo:[0,1,0] neg_hi:[0,1,0]
  v_pk_fma_f32 v[158:159], v[66:67], v[182:183], v[158:159] op_sel_hi:[1,0,1] neg_lo:[0,1,0] neg_hi:[0,1,0]
  v_pk_fma_f32 v[160:161], v[68:69], v[182:183], v[160:161] op_sel_hi:[1,0,1] neg_lo:[0,1,0] neg_hi:[0,1,0]
  v_pk_fma_f32 v[162:163], v[70:71], v[182:183], v[162:163] op_sel_hi:[1,0,1] neg_lo:[0,1,0] neg_hi:[0,1,0]
  v_pk_mul_f32 v[148:149], v[148:149], v[188:189] op_sel_hi:[1,0]
  v_pk_mul_f32 v[150:151], v[150:151], v[188:189] op_sel_hi:[1,0]
  v_pk_mul_f32 v[152:153], v[152:153], v[188:189] op_sel_hi:[1,0]
  v_pk_mul_f32 v[154:155], v[154:155], v[188:189] op_sel_hi:[1,0]
  v_pk_mul_f32 v[156:157], v[156:157], v[190:191] op_sel_hi:[1,0]
  v_pk_mul_f32 v[158:159], v[158:159], v[190:191] op_sel_hi:[1,0]
  v_pk_mul_f32 v[160:161], v[160:161], v[190:191] op_sel_hi:[1,0]
  v_pk_mul_f32 v[162:163], v[162:163], v[190:191] op_sel_hi:[1,0]
  v_pk_mul_f32 v[196:197], v[148:149], v[148:149]
  v_pk_mul_f32 v[198:199], v[150:151], v[150:151]
  v_pk_mul_f32 v[200:201], v[152:153], v[152:153]
  v_pk_mul_f32 v[202:203], v[154:155], v[154:155]
  v_pk_mul_f32 v[204:205], v[156:157], v[156:157]
  v_pk_mul_f32 v[206:207], v[158:159], v[158:159]
  v_pk_mul_f32 v[208:209], v[160:161], v[160:161]
  v_pk_mul_f32 v[210:211], v[162:163], v[162:163]
  v_pk_fma_f32 v[196:197], v[196:197], s[84:85], v[62:63]
  v_pk_fma_f32 v[198:199], v[198:199], s[84:85], v[62:63]
  v_pk_fma_f32 v[200:201], v[200:201], s[84:85], v[62:63]
  v_pk_fma_f32 v[202:203], v[202:203], s[84:85], v[62:63]
  v_pk_fma_f32 v[204:205], v[204:205], s[84:85], v[62:63]
  v_pk_fma_f32 v[206:207], v[206:207], s[84:85], v[62:63]
  v_pk_fma_f32 v[208:209], v[208:209], s[84:85], v[62:63]
  v_pk_fma_f32 v[210:211], v[210:211], s[84:85], v[62:63]
  v_pk_mul_f32 v[196:197], v[196:197], v[148:149]
  v_pk_mul_f32 v[198:199], v[198:199], v[150:151]
  v_pk_mul_f32 v[200:201], v[200:201], v[152:153]
  v_pk_mul_f32 v[202:203], v[202:203], v[154:155]
  v_pk_mul_f32 v[204:205], v[204:205], v[156:157]
  v_pk_mul_f32 v[206:207], v[206:207], v[158:159]
  v_pk_mul_f32 v[208:209], v[208:209], v[160:161]
  v_pk_mul_f32 v[210:211], v[210:211], v[162:163]
  v_exp_f32 v196, v196
  v_exp_f32 v197, v197
  v_exp_f32 v198, v198
  v_exp_f32 v199, v199
  v_exp_f32 v200, v200
  v_exp_f32 v201, v201
  v_exp_f32 v202, v202
  v_exp_f32 v203, v203
  v_exp_f32 v204, v204
  v_exp_f32 v205, v205
  v_exp_f32 v206, v206
  v_exp_f32 v207, v207
  v_exp_f32 v208, v208
  v_exp_f32 v209, v209
  v_exp_f32 v210, v210
  v_exp_f32 v211, v211
  v_pk_add_f32 v[196:197], v[196:197], 1.0 op_sel_hi:[1,0]
  v_pk_add_f32 v[198:199], v[198:199], 1.0 op_sel_hi:[1,0]
  v_pk_add_f32 v[200:201], v[200:201], 1.0 op_sel_hi:[1,0]
  v_pk_add_f32 v[202:203], v[202:203], 1.0 op_sel_hi:[1,0]
  v_pk_add_f32 v[204:205], v[204:205], 1.0 op_sel_hi:[1,0]
  v_pk_add_f32 v[206:207], v[206:207], 1.0 op_sel_hi:[1,0]
  v_pk_add_f32 v[208:209], v[208:209], 1.0 op_sel_hi:[1,0]
  v_pk_add_f32 v[210:211], v[210:211], 1.0 op_sel_hi:[1,0]
  v_rcp_f32 v196, v196
  v_rcp_f32 v197, v197
  v_rcp_f32 v198, v198
  v_rcp_f32 v199, v199
  v_rcp_f32 v200, v200
  v_rcp_f32 v201, v201
  v_rcp_f32 v202, v202
  v_rcp_f32 v203, v203
  v_rcp_f32 v204, v204
  v_rcp_f32 v205, v205
  v_rcp_f32 v206, v206
  v_rcp_f32 v207, v207
  v_rcp_f32 v208, v208
  v_rcp_f32 v209, v209
  v_rcp_f32 v210, v210
  v_rcp_f32 v211, v211
  v_pk_mul_f32 v[148:149], v[148:149], v[196:197]
  v_pk_mul_f32 v[150:151], v[150:151], v[198:199]
  v_pk_mul_f32 v[152:153], v[152:153], v[200:201]
  v_pk_mul_f32 v[154:155], v[154:155], v[202:203]
  v_pk_mul_f32 v[156:157], v[156:157], v[204:205]
  v_pk_mul_f32 v[158:159], v[158:159], v[206:207]
  v_pk_mul_f32 v[160:161], v[160:161], v[208:209]
  v_pk_mul_f32 v[162:163], v[162:163], v[210:211]
  v_cvt_pk_bf16_f32 v212, v148, v149
  v_cvt_pk_bf16_f32 v213, v150, v151
  v_cvt_pk_bf16_f32 v214, v152, v153
  v_cvt_pk_bf16_f32 v215, v154, v155
  s_nop 0
  v_permlane16_swap_b32 v212, v214
  v_permlane16_swap_b32 v213, v215
  buffer_store_dwordx4 v[212:215], v94, s[36:39], 0 offen sc1
  v_cvt_pk_bf16_f32 v216, v156, v157
  v_cvt_pk_bf16_f32 v217, v158, v159
  v_cvt_pk_bf16_f32 v218, v160, v161
  v_cvt_pk_bf16_f32 v219, v162, v163
  s_nop 0
  v_permlane16_swap_b32 v216, v218
  v_permlane16_swap_b32 v217, v219
  buffer_store_dwordx4 v[216:219], v95, s[36:39], 0 offen sc1
  v_mov_b32 v148, 0
  v_mov_b32 v149, 0
  v_mov_b32 v150, 0
  v_mov_b32 v151, 0
  v_mov_b32 v152, 0
  v_mov_b32 v153, 0
  v_mov_b32 v154, 0
  v_mov_b32 v155, 0
  v_mov_b32 v156, 0
  v_mov_b32 v157, 0
  v_mov_b32 v158, 0
  v_mov_b32 v159, 0
  v_mov_b32 v160, 0
  v_mov_b32 v161, 0
  v_mov_b32 v162, 0
  v_mov_b32 v163, 0
  v_mov_b32 v164, 0
  v_mov_b32 v165, 0
  v_mov_b32 v166, 0
  v_mov_b32 v167, 0
  v_mov_b32 v168, 0
  v_mov_b32 v169, 0
  v_mov_b32 v170, 0
  v_mov_b32 v171, 0
  v_mov_b32 v172, 0
  v_mov_b32 v173, 0
  v_mov_b32 v174, 0
  v_mov_b32 v175, 0
  v_mov_b32 v176, 0
  v_mov_b32 v177, 0
  v_mov_b32 v178, 0
  v_mov_b32 v179, 0
  v_mov_b32 v236, 0
  v_mov_b32 v237, 0
  v_mov_b32 v238, 0
  v_mov_b32 v239, 0
  v_mov_b32 v240, 0
  v_mov_b32 v241, 0
  v_mov_b32 v242, 0
  v_mov_b32 v243, 0
  v_mov_b32 v244, 0
  v_mov_b32 v245, 0
  v_mov_b32 v246, 0
  v_mov_b32 v247, 0
  v_mov_b32 v248, 0
  v_mov_b32 v249, 0
  v_mov_b32 v250, 0
  v_mov_b32 v251, 0
  v_mov_b32 v32, 0
  v_mov_b32 v33, 0
  v_mov_b32 v34, 0
  v_mov_b32 v35, 0
  v_mov_b32 v36, 0
  v_mov_b32 v37, 0
  v_mov_b32 v38, 0
  v_mov_b32 v39, 0
  v_mov_b32 v40, 0
  v_mov_b32 v41, 0
  v_mov_b32 v42, 0
  v_mov_b32 v43, 0
  s_barrier
  ds_read_b128 v[180:183], v92 offset:0
  ds_read_b64_tr_b16 v[196:197], v96 offset:0
  ds_read_b64_tr_b16 v[198:199], v96 offset:512
  ds_read_b128 v[184:187], v92 offset:2048
  ds_read_b64_tr_b16 v[200:201], v96 offset:8192
  ds_read_b64_tr_b16 v[202:203], v96 offset:8704
  ds_read_b128 v[188:191], v92 offset:4096
  ds_read_b64_tr_b16 v[204:205], v96 offset:16384
  ds_read_b64_tr_b16 v[206:207], v96 offset:16896
  ds_read_b128 v[192:195], v92 offset:6144
  s_waitcnt lgkmcnt(7)
  v_mfma_f32_16x16x32_bf16 v[148:151], v[196:199], v[180:183], v[148:151]
  ds_read_b128 v[208:211], v93 offset:0
  s_waitcnt lgkmcnt(7)
  v_mfma_f32_16x16x32_bf16 v[152:155], v[196:199], v[184:187], v[152:155]
  ds_read_b64_tr_b16 v[224:225], v96 offset:4096
  s_waitcnt lgkmcnt(5)
  v_mfma_f32_16x16x32_bf16 v[156:159], v[196:199], v[188:191], v[156:159]
  ds_read_b64_tr_b16 v[226:227], v96 offset:4608
  s_waitcnt lgkmcnt(3)
  v_mfma_f32_16x16x32_bf16 v[160:163], v[196:199], v[192:195], v[160:163]
  ds_read_b128 v[212:215], v93 offset:2048
  v_mfma_f32_16x16x32_bf16 v[32:35], v[196:199], v[28:31], v[32:35]
  ds_read_b64_tr_b16 v[228:229], v96 offset:12288
  v_mfma_f32_16x16x32_bf16 v[164:167], v[200:203], v[180:183], v[164:167]
  ds_read_b64_tr_b16 v[230:231], v96 offset:12800
  v_mfma_f32_16x16x32_bf16 v[168:171], v[200:203], v[184:187], v[168:171]
  ds_read_b128 v[216:219], v93 offset:4096
  v_mfma_f32_16x16x32_bf16 v[172:175], v[200:203], v[188:191], v[172:175]
  ds_read_b64_tr_b16 v[232:233], v96 offset:20480
  v_mfma_f32_16x16x32_bf16 v[176:179], v[200:203], v[192:195], v[176:179]
  ds_read_b64_tr_b16 v[234:235], v96 offset:20992
  v_mfma_f32_16x16x32_bf16 v[36:39], v[200:203], v[28:31], v[36:39]
  ds_read_b128 v[220:223], v93 offset:6144
  v_mfma_f32_16x16x32_bf16 v[236:239], v[180:183], v[204:207], v[236:239]
  v_mfma_f32_16x16x32_bf16 v[240:243], v[184:187], v[204:207], v[240:243]
  v_mfma_f32_16x16x32_bf16 v[244:247], v[188:191], v[204:207], v[244:247]
  v_mfma_f32_16x16x32_bf16 v[248:251], v[192:195], v[204:207], v[248:251]
  v_mfma_f32_16x16x32_bf16 v[40:43], v[28:31], v[204:207], v[40:43]
  s_waitcnt lgkmcnt(0)
  s_barrier
  v_mfma_f32_16x16x32_bf16 v[148:151], v[224:227], v[208:211], v[148:151]
  ds_read_b128 v[180:183], v92 offset:8192
  v_mfma_f32_16x16x32_bf16 v[152:155], v[224:227], v[212:215], v[152:155]
  ds_read_b64_tr_b16 v[196:197], v97 offset:0
  v_mfma_f32_16x16x32_bf16 v[156:159], v[224:227], v[216:219], v[156:159]
  ds_read_b64_tr_b16 v[198:199], v97 offset:512
  v_mfma_f32_16x16x32_bf16 v[160:163], v[224:227], v[220:223], v[160:163]
  ds_read_b128 v[184:187], v92 offset:10240
  v_mfma_f32_16x16x32_bf16 v[32:35], v[224:227], v[28:31], v[32:35]
  ds_read_b64_tr_b16 v[200:201], v97 offset:8192
  v_mfma_f32_16x16x32_bf16 v[164:167], v[228:231], v[208:211], v[164:167]
  ds_read_b64_tr_b16 v[202:203], v97 offset:8704
  v_mfma_f32_16x16x32_bf16 v[168:171], v[228:231], v[212:215], v[168:171]
  ds_read_b128 v[188:191], v92 offset:12288
  v_mfma_f32_16x16x32_bf16 v[172:175], v[228:231], v[216:219], v[172:175]
  ds_read_b64_tr_b16 v[204:205], v97 offset:16384
  v_mfma_f32_16x16x32_bf16 v[176:179], v[228:231], v[220:223], v[176:179]
  ds_read_b64_tr_b16 v[206:207], v97 offset:16896
  v_mfma_f32_16x16x32_bf16 v[36:39], v[228:231], v[28:31], v[36:39]
  ds_read_b128 v[192:195], v92 offset:14336
  v_mfma_f32_16x16x32_bf16 v[236:239], v[208:211], v[232:235], v[236:239]
  v_mfma_f32_16x16x32_bf16 v[240:243], v[212:215], v[232:235], v[240:243]
  v_mfma_f32_16x16x32_bf16 v[244:247], v[216:219], v[232:235], v[244:247]
  v_mfma_f32_16x16x32_bf16 v[248:251], v[220:223], v[232:235], v[248:251]
  v_mfma_f32_16x16x32_bf16 v[40:43], v[28:31], v[232:235], v[40:43]
  s_waitcnt lgkmcnt(7)
  v_mfma_f32_16x16x32_bf16 v[148:151], v[196:199], v[180:183], v[148:151]
  ds_read_b128 v[208:211], v93 offset:8192
  s_waitcnt lgkmcnt(7)
  v_mfma_f32_16x16x32_bf16 v[152:155], v[196:199], v[184:187], v[152:155]
  ds_read_b64_tr_b16 v[224:225], v97 offset:4096
  s_waitcnt lgkmcnt(5)
  v_mfma_f32_16x16x32_bf16 v[156:159], v[196:199], v[188:191], v[156:159]
  ds_read_b64_tr_b16 v[226:227], v97 offset:4608
  s_waitcnt lgkmcnt(3)
  v_mfma_f32_16x16x32_bf16 v[160:163], v[196:199], v[192:195], v[160:163]
  ds_read_b128 v[212:215], v93 offset:10240
  v_mfma_f32_16x16x32_bf16 v[32:35], v[196:199], v[28:31], v[32:35]
  ds_read_b64_tr_b16 v[228:229], v97 offset:12288
  v_mfma_f32_16x16x32_bf16 v[164:167], v[200:203], v[180:183], v[164:167]
  ds_read_b64_tr_b16 v[230:231], v97 offset:12800
  v_mfma_f32_16x16x32_bf16 v[168:171], v[200:203], v[184:187], v[168:171]
  ds_read_b128 v[216:219], v93 offset:12288
  v_mfma_f32_16x16x32_bf16 v[172:175], v[200:203], v[188:191], v[172:175]
  ds_read_b64_tr_b16 v[232:233], v97 offset:20480
  v_mfma_f32_16x16x32_bf16 v[176:179], v[200:203], v[192:195], v[176:179]
  ds_read_b64_tr_b16 v[234:235], v97 offset:20992
  v_mfma_f32_16x16x32_bf16 v[36:39], v[200:203], v[28:31], v[36:39]
  ds_read_b128 v[220:223], v93 offset:14336
  v_mfma_f32_16x16x32_bf16 v[236:239], v[180:183], v[204:207], v[236:239]
  v_mfma_f32_16x16x32_bf16 v[240:243], v[184:187], v[204:207], v[240:243]
  v_mfma_f32_16x16x32_bf16 v[244:247], v[188:191], v[204:207], v[244:247]
  v_mfma_f32_16x16x32_bf16 v[248:251], v[192:195], v[204:207], v[248:251]
  v_mfma_f32_16x16x32_bf16 v[40:43], v[28:31], v[204:207], v[40:43]
  s_waitcnt lgkmcnt(0)
  s_barrier
  v_mfma_f32_16x16x32_bf16 v[148:151], v[224:227], v[208:211], v[148:151]
  ds_read_b128 v[180:183], v92 offset:16384
  v_mfma_f32_16x16x32_bf16 v[152:155], v[224:227], v[212:215], v[152:155]
  ds_read_b64_tr_b16 v[196:197], v98 offset:0
  v_mfma_f32_16x16x32_bf16 v[156:159], v[224:227], v[216:219], v[156:159]
  ds_read_b64_tr_b16 v[198:199], v98 offset:512
  v_mfma_f32_16x16x32_bf16 v[160:163], v[224:227], v[220:223], v[160:163]
  ds_read_b128 v[184:187], v92 offset:18432
  v_mfma_f32_16x16x32_bf16 v[32:35], v[224:227], v[28:31], v[32:35]
  ds_read_b64_tr_b16 v[200:201], v98 offset:8192
  v_mfma_f32_16x16x32_bf16 v[164:167], v[228:231], v[208:211], v[164:167]
  ds_read_b64_tr_b16 v[202:203], v98 offset:8704
  v_mfma_f32_16x16x32_bf16 v[168:171], v[228:231], v[212:215], v[168:171]
  ds_read_b128 v[188:191], v92 offset:20480
  v_mfma_f32_16x16x32_bf16 v[172:175], v[228:231], v[216:219], v[172:175]
  ds_read_b64_tr_b16 v[204:205], v98 offset:16384
  v_mfma_f32_16x16x32_bf16 v[176:179], v[228:231], v[220:223], v[176:179]
  ds_read_b64_tr_b16 v[206:207], v98 offset:16896
  v_mfma_f32_16x16x32_bf16 v[36:39], v[228:231], v[28:31], v[36:39]
  ds_read_b128 v[192:195], v92 offset:22528
  v_mfma_f32_16x16x32_bf16 v[236:239], v[208:211], v[232:235], v[236:239]
  v_mfma_f32_16x16x32_bf16 v[240:243], v[212:215], v[232:235], v[240:243]
  v_mfma_f32_16x16x32_bf16 v[244:247], v[216:219], v[232:235], v[244:247]
  v_mfma_f32_16x16x32_bf16 v[248:251], v[220:223], v[232:235], v[248:251]
  v_mfma_f32_16x16x32_bf16 v[40:43], v[28:31], v[232:235], v[40:43]
  s_waitcnt lgkmcnt(7)
  v_mfma_f32_16x16x32_bf16 v[148:151], v[196:199], v[180:183], v[148:151]
  ds_read_b128 v[208:211], v93 offset:16384
  s_waitcnt lgkmcnt(7)
  v_mfma_f32_16x16x32_bf16 v[152:155], v[196:199], v[184:187], v[152:155]
  ds_read_b64_tr_b16 v[224:225], v98 offset:4096
  s_waitcnt lgkmcnt(5)
  v_mfma_f32_16x16x32_bf16 v[156:159], v[196:199], v[188:191], v[156:159]
  ds_read_b64_tr_b16 v[226:227], v98 offset:4608
  s_waitcnt lgkmcnt(3)
  v_mfma_f32_16x16x32_bf16 v[160:163], v[196:199], v[192:195], v[160:163]
  ds_read_b128 v[212:215], v93 offset:18432
  v_mfma_f32_16x16x32_bf16 v[32:35], v[196:199], v[28:31], v[32:35]
  ds_read_b64_tr_b16 v[228:229], v98 offset:12288
  v_mfma_f32_16x16x32_bf16 v[164:167], v[200:203], v[180:183], v[164:167]
  ds_read_b64_tr_b16 v[230:231], v98 offset:12800
  v_mfma_f32_16x16x32_bf16 v[168:171], v[200:203], v[184:187], v[168:171]
  ds_read_b128 v[216:219], v93 offset:20480
  v_mfma_f32_16x16x32_bf16 v[172:175], v[200:203], v[188:191], v[172:175]
  ds_read_b64_tr_b16 v[232:233], v98 offset:20480
  v_mfma_f32_16x16x32_bf16 v[176:179], v[200:203], v[192:195], v[176:179]
  ds_read_b64_tr_b16 v[234:235], v98 offset:20992
  v_mfma_f32_16x16x32_bf16 v[36:39], v[200:203], v[28:31], v[36:39]
  ds_read_b128 v[220:223], v93 offset:22528
  v_mfma_f32_16x16x32_bf16 v[236:239], v[180:183], v[204:207], v[236:239]
  v_mfma_f32_16x16x32_bf16 v[240:243], v[184:187], v[204:207], v[240:243]
  v_mfma_f32_16x16x32_bf16 v[244:247], v[188:191], v[204:207], v[244:247]
  v_mfma_f32_16x16x32_bf16 v[248:251], v[192:195], v[204:207], v[248:251]
  v_mfma_f32_16x16x32_bf16 v[40:43], v[28:31], v[204:207], v[40:43]
  s_waitcnt lgkmcnt(0)
  s_waitcnt vmcnt(0)
  v_readfirstlane_b32 s49, v144
  s_nop 3
  s_add_u32 s49, s49, 8
  s_add_u32 s74, s49, 1
  v_mov_b32 v4, s74
  v_mov_b32 v5, s67
  s_mov_b64 exec, 1
  buffer_store_dword v4, v5, s[36:39], 0 offen sc1
  s_mov_b64 exec, -1
  s_cmp_eq_u32 s48, 1
  s_cbranch_scc0 LC_mw_3
  s_mul_i32 s74, s50, 5504
  v_lshlrev_b32 v4, 7, v1
  v_mov_b32 v12, 2130706432
  v_cmp_gt_u32 vcc, 5504, v4
  s_nop 1
  v_cndmask_b32 v4, v12, v4, vcc
  buffer_load_dword v13, v4, s[24:27], s74 offen
LC_mw_3:
  s_cmp_eq_u32 s48, 2
  s_cbranch_scc0 LC_mw_4
  s_mul_i32 s74, s50, 2048
  v_lshlrev_b32 v4, 7, v1
  v_mov_b32 v12, 2130706432
  v_cmp_gt_u32 vcc, 2048, v4
  s_nop 1
  v_cndmask_b32 v4, v12, v4, vcc
  buffer_load_dword v13, v4, s[20:23], s74 offen
LC_mw_4:
  s_cmp_eq_u32 s48, 3
  s_cbranch_scc0 LC_mw_5
  s_mul_i32 s74, s50, 5504
  v_lshlrev_b32 v4, 7, v1
  v_mov_b32 v12, 2130706432
  v_cmp_gt_u32 vcc, 5504, v4
  s_nop 1
  v_cndmask_b32 v4, v12, v4, vcc
  buffer_load_dword v13, v4, s[28:31], s74 offen
LC_mw_5:
  s_barrier
  v_mfma_f32_16x16x32_bf16 v[148:151], v[224:227], v[208:211], v[148:151]
  ds_read_b128 v[180:183], v92 offset:24576
  v_mfma_f32_16x16x32_bf16 v[152:155], v[224:227], v[212:215], v[152:155]
  ds_read_b64_tr_b16 v[196:197], v96 offset:0
  v_mfma_f32_16x16x32_bf16 v[156:159], v[224:227], v[216:219], v[156:159]
  ds_read_b64_tr_b16 v[198:199], v96 offset:512
  v_mfma_f32_16x16x32_bf16 v[160:163], v[224:227], v[220:223], v[160:163]
  ds_read_b128 v[184:187], v92 offset:26624
  v_mfma_f32_16x16x32_bf16 v[32:35], v[224:227], v[28:31], v[32:35]
  ds_read_b64_tr_b16 v[200:201], v96 offset:8192
  v_mfma_f32_16x16x32_bf16 v[164:167], v[228:231], v[208:211], v[164:167]
  ds_read_b64_tr_b16 v[202:203], v96 offset:8704
  v_mfma_f32_16x16x32_bf16 v[168:171], v[228:231], v[212:215], v[168:171]
  ds_read_b128 v[188:191], v92 offset:28672
  v_mfma_f32_16x16x32_bf16 v[172:175], v[228:231], v[216:219], v[172:175]
  ds_read_b64_tr_b16 v[204:205], v96 offset:16384
  v_mfma_f32_16x16x32_bf16 v[176:179], v[228:231], v[220:223], v[176:179]
  ds_read_b64_tr_b16 v[206:207], v96 offset:16896
  v_mfma_f32_16x16x32_bf16 v[36:39], v[228:231], v[28:31], v[36:39]
  ds_read_b128 v[192:195], v92 offset:30720
  v_mfma_f32_16x16x32_bf16 v[236:239], v[208:211], v[232:235], v[236:239]
  v_mfma_f32_16x16x32_bf16 v[240:243], v[212:215], v[232:235], v[240:243]
  v_mfma_f32_16x16x32_bf16 v[244:247], v[216:219], v[232:235], v[244:247]
  v_mfma_f32_16x16x32_bf16 v[248:251], v[220:223], v[232:235], v[248:251]
  v_mfma_f32_16x16x32_bf16 v[40:43], v[28:31], v[232:235], v[40:43]
  s_waitcnt lgkmcnt(7)
  v_mfma_f32_16x16x32_bf16 v[148:151], v[196:199], v[180:183], v[148:151]
  ds_read_b128 v[208:211], v93 offset:24576
  s_waitcnt lgkmcnt(7)
  v_mfma_f32_16x16x32_bf16 v[152:155], v[196:199], v[184:187], v[152:155]
  ds_read_b64_tr_b16 v[224:225], v96 offset:4096
  s_waitcnt lgkmcnt(5)
  v_mfma_f32_16x16x32_bf16 v[156:159], v[196:199], v[188:191], v[156:159]
  ds_read_b64_tr_b16 v[226:227], v96 offset:4608
  s_waitcnt lgkmcnt(3)
  v_mfma_f32_16x16x32_bf16 v[160:163], v[196:199], v[192:195], v[160:163]
  ds_read_b128 v[212:215], v93 offset:26624
  v_mfma_f32_16x16x32_bf16 v[32:35], v[196:199], v[28:31], v[32:35]
  ds_read_b64_tr_b16 v[228:229], v96 offset:12288
  v_mfma_f32_16x16x32_bf16 v[164:167], v[200:203], v[180:183], v[164:167]
  ds_read_b64_tr_b16 v[230:231], v96 offset:12800
  v_mfma_f32_16x16x32_bf16 v[168:171], v[200:203], v[184:187], v[168:171]
  ds_read_b128 v[216:219], v93 offset:28672
  v_mfma_f32_16x16x32_bf16 v[172:175], v[200:203], v[188:191], v[172:175]
  ds_read_b64_tr_b16 v[232:233], v96 offset:20480
  v_mfma_f32_16x16x32_bf16 v[176:179], v[200:203], v[192:195], v[176:179]
  ds_read_b64_tr_b16 v[234:235], v96 offset:20992
  v_mfma_f32_16x16x32_bf16 v[36:39], v[200:203], v[28:31], v[36:39]
  ds_read_b128 v[220:223], v93 offset:30720
  v_mfma_f32_16x16x32_bf16 v[236:239], v[180:183], v[204:207], v[236:239]
  v_mfma_f32_16x16x32_bf16 v[240:243], v[184:187], v[204:207], v[240:243]
  v_mfma_f32_16x16x32_bf16 v[244:247], v[188:191], v[204:207], v[244:247]
  v_mfma_f32_16x16x32_bf16 v[248:251], v[192:195], v[204:207], v[248:251]
  v_mfma_f32_16x16x32_bf16 v[40:43], v[28:31], v[204:207], v[40:43]
  s_waitcnt lgkmcnt(0)
  s_barrier
  v_mfma_f32_16x16x32_bf16 v[148:151], v[224:227], v[208:211], v[148:151]
  ds_read_b128 v[180:183], v92 offset:32768
  v_mfma_f32_16x16x32_bf16 v[152:155], v[224:227], v[212:215], v[152:155]
  ds_read_b64_tr_b16 v[196:197], v97 offset:0
  v_mfma_f32_16x16x32_bf16 v[156:159], v[224:227], v[216:219], v[156:159]
  ds_read_b64_tr_b16 v[198:199], v97 offset:512
  v_mfma_f32_16x16x32_bf16 v[160:163], v[224:227], v[220:223], v[160:163]
  ds_read_b128 v[184:187], v92 offset:34816
  v_mfma_f32_16x16x32_bf16 v[32:35], v[224:227], v[28:31], v[32:35]
  ds_read_b64_tr_b16 v[200:201], v97 offset:8192
  v_mfma_f32_16x16x32_bf16 v[164:167], v[228:231], v[208:211], v[164:167]
  ds_read_b64_tr_b16 v[202:203], v97 offset:8704
  v_mfma_f32_16x16x32_bf16 v[168:171], v[228:231], v[212:215], v[168:171]
  ds_read_b128 v[188:191], v92 offset:36864
  v_mfma_f32_16x16x32_bf16 v[172:175], v[228:231], v[216:219], v[172:175]
  ds_read_b64_tr_b16 v[204:205], v97 offset:16384
  v_mfma_f32_16x16x32_bf16 v[176:179], v[228:231], v[220:223], v[176:179]
  ds_read_b64_tr_b16 v[206:207], v97 offset:16896
  v_mfma_f32_16x16x32_bf16 v[36:39], v[228:231], v[28:31], v[36:39]
  ds_read_b128 v[192:195], v92 offset:38912
  v_mfma_f32_16x16x32_bf16 v[236:239], v[208:211], v[232:235], v[236:239]
  v_mfma_f32_16x16x32_bf16 v[240:243], v[212:215], v[232:235], v[240:243]
  v_mfma_f32_16x16x32_bf16 v[244:247], v[216:219], v[232:235], v[244:247]
  v_mfma_f32_16x16x32_bf16 v[248:251], v[220:223], v[232:235], v[248:251]
  v_mfma_f32_16x16x32_bf16 v[40:43], v[28:31], v[232:235], v[40:43]
  s_waitcnt lgkmcnt(7)
  v_mfma_f32_16x16x32_bf16 v[148:151], v[196:199], v[180:183], v[148:151]
  ds_read_b128 v[208:211], v93 offset:32768
  s_waitcnt lgkmcnt(7)
  v_mfma_f32_16x16x32_bf16 v[152:155], v[196:199], v[184:187], v[152:155]
  ds_read_b64_tr_b16 v[224:225], v97 offset:4096
  s_waitcnt lgkmcnt(5)
  v_mfma_f32_16x16x32_bf16 v[156:159], v[196:199], v[188:191], v[156:159]
  ds_read_b64_tr_b16 v[226:227], v97 offset:4608
  s_waitcnt lgkmcnt(3)
  v_mfma_f32_16x16x32_bf16 v[160:163], v[196:199], v[192:195], v[160:163]
  ds_read_b128 v[212:215], v93 offset:34816
  v_mfma_f32_16x16x32_bf16 v[32:35], v[196:199], v[28:31], v[32:35]
  ds_read_b64_tr_b16 v[228:229], v97 offset:12288
  v_mfma_f32_16x16x32_bf16 v[164:167], v[200:203], v[180:183], v[164:167]
  ds_read_b64_tr_b16 v[230:231], v97 offset:12800
  v_mfma_f32_16x16x32_bf16 v[168:171], v[200:203], v[184:187], v[168:171]
  ds_read_b128 v[216:219], v93 offset:36864
  v_mfma_f32_16x16x32_bf16 v[172:175], v[200:203], v[188:191], v[172:175]
  ds_read_b64_tr_b16 v[232:233], v97 offset:20480
  v_mfma_f32_16x16x32_bf16 v[176:179], v[200:203], v[192:195], v[176:179]
  ds_read_b64_tr_b16 v[234:235], v97 offset:20992
  v_mfma_f32_16x16x32_bf16 v[36:39], v[200:203], v[28:31], v[36:39]
  ds_read_b128 v[220:223], v93 offset:38912
  v_mfma_f32_16x16x32_bf16 v[236:239], v[180:183], v[204:207], v[236:239]
  v_mfma_f32_16x16x32_bf16 v[240:243], v[184:187], v[204:207], v[240:243]
  v_mfma_f32_16x16x32_bf16 v[244:247], v[188:191], v[204:207], v[244:247]
  v_mfma_f32_16x16x32_bf16 v[248:251], v[192:195], v[204:207], v[248:251]
  v_mfma_f32_16x16x32_bf16 v[40:43], v[28:31], v[204:207], v[40:43]
  s_waitcnt lgkmcnt(0)
  s_barrier
  v_mfma_f32_16x16x32_bf16 v[148:151], v[224:227], v[208:211], v[148:151]
  ds_read_b128 v[180:183], v92 offset:40960
  v_mfma_f32_16x16x32_bf16 v[152:155], v[224:227], v[212:215], v[152:155]
  ds_read_b64_tr_b16 v[196:197], v98 offset:0
  v_mfma_f32_16x16x32_bf16 v[156:159], v[224:227], v[216:219], v[156:159]
  ds_read_b64_tr_b16 v[198:199], v98 offset:512
  v_mfma_f32_16x16x32_bf16 v[160:163], v[224:227], v[220:223], v[160:163]
  ds_read_b128 v[184:187], v92 offset:43008
  v_mfma_f32_16x16x32_bf16 v[32:35], v[224:227], v[28:31], v[32:35]
  ds_read_b64_tr_b16 v[200:201], v98 offset:8192
  v_mfma_f32_16x16x32_bf16 v[164:167], v[228:231], v[208:211], v[164:167]
  ds_read_b64_tr_b16 v[202:203], v98 offset:8704
  v_mfma_f32_16x16x32_bf16 v[168:171], v[228:231], v[212:215], v[168:171]
  ds_read_b128 v[188:191], v92 offset:45056
  v_mfma_f32_16x16x32_bf16 v[172:175], v[228:231], v[216:219], v[172:175]
  ds_read_b64_tr_b16 v[204:205], v98 offset:16384
  v_mfma_f32_16x16x32_bf16 v[176:179], v[228:231], v[220:223], v[176:179]
  ds_read_b64_tr_b16 v[206:207], v98 offset:16896
  v_mfma_f32_16x16x32_bf16 v[36:39], v[228:231], v[28:31], v[36:39]
  ds_read_b128 v[192:195], v92 offset:47104
  v_mfma_f32_16x16x32_bf16 v[236:239], v[208:211], v[232:235], v[236:239]
  v_mfma_f32_16x16x32_bf16 v[240:243], v[212:215], v[232:235], v[240:243]
  v_mfma_f32_16x16x32_bf16 v[244:247], v[216:219], v[232:235], v[244:247]
  v_mfma_f32_16x16x32_bf16 v[248:251], v[220:223], v[232:235], v[248:251]
  v_mfma_f32_16x16x32_bf16 v[40:43], v[28:31], v[232:235], v[40:43]
  s_waitcnt lgkmcnt(7)
  v_mfma_f32_16x16x32_bf16 v[148:151], v[196:199], v[180:183], v[148:151]
  ds_read_b128 v[208:211], v93 offset:40960
  s_waitcnt lgkmcnt(7)
  v_mfma_f32_16x16x32_bf16 v[152:155], v[196:199], v[184:187], v[152:155]
  ds_read_b64_tr_b16 v[224:225], v98 offset:4096
  s_waitcnt lgkmcnt(5)
  v_mfma_f32_16x16x32_bf16 v[156:159], v[196:199], v[188:191], v[156:159]
  ds_read_b64_tr_b16 v[226:227], v98 offset:4608
  s_waitcnt lgkmcnt(3)
  v_mfma_f32_16x16x32_bf16 v[160:163], v[196:199], v[192:195], v[160:163]
  ds_read_b128 v[212:215], v93 offset:43008
  v_mfma_f32_16x16x32_bf16 v[32:35], v[196:199], v[28:31], v[32:35]
  ds_read_b64_tr_b16 v[228:229], v98 offset:12288
  v_mfma_f32_16x16x32_bf16 v[164:167], v[200:203], v[180:183], v[164:167]
  ds_read_b64_tr_b16 v[230:231], v98 offset:12800
  v_mfma_f32_16x16x32_bf16 v[168:171], v[200:203], v[184:187], v[168:171]
  ds_read_b128 v[216:219], v93 offset:45056
  v_mfma_f32_16x16x32_bf16 v[172:175], v[200:203], v[188:191], v[172:175]
  ds_read_b64_tr_b16 v[232:233], v98 offset:20480
  v_mfma_f32_16x16x32_bf16 v[176:179], v[200:203], v[192:195], v[176:179]
  ds_read_b64_tr_b16 v[234:235], v98 offset:20992
  v_mfma_f32_16x16x32_bf16 v[36:39], v[200:203], v[28:31], v[36:39]
  ds_read_b128 v[220:223], v93 offset:47104
  v_mfma_f32_16x16x32_bf16 v[236:239], v[180:183], v[204:207], v[236:239]
  v_mfma_f32_16x16x32_bf16 v[240:243], v[184:187], v[204:207], v[240:243]
  v_mfma_f32_16x16x32_bf16 v[244:247], v[188:191], v[204:207], v[244:247]
  v_mfma_f32_16x16x32_bf16 v[248:251], v[192:195], v[204:207], v[248:251]
  v_mfma_f32_16x16x32_bf16 v[40:43], v[28:31], v[204:207], v[40:43]
  s_waitcnt lgkmcnt(0)
  s_barrier
  s_cmp_eq_u32 s48, 0
  s_cbranch_scc0 LC_pe_6
  buffer_load_dwordx4 v[144:147], v136, s[36:39], 0 offen sc1
LC_pe_6:
  v_mfma_f32_16x16x32_bf16 v[148:151], v[224:227], v[208:211], v[148:151]
  ds_read_b128 v[180:183], v92 offset:49152
  v_mfma_f32_16x16x32_bf16 v[152:155], v[224:227], v[212:215], v[152:155]
  ds_read_b64_tr_b16 v[196:197], v96 offset:0
  v_mfma_f32_16x16x32_bf16 v[156:159], v[224:227], v[216:219], v[156:159]
  ds_read_b64_tr_b16 v[198:199], v96 offset:512
  v_mfma_f32_16x16x32_bf16 v[160:163], v[224:227], v[220:223], v[160:163]
  ds_read_b128 v[184:187], v92 offset:51200
  v_mfma_f32_16x16x32_bf16 v[32:35], v[224:227], v[28:31], v[32:35]
  ds_read_b64_tr_b16 v[200:201], v96 offset:8192
  v_mfma_f32_16x16x32_bf16 v[164:167], v[228:231], v[208:211], v[164:167]
  ds_read_b64_tr_b16 v[202:203], v96 offset:8704
  v_mfma_f32_16x16x32_bf16 v[168:171], v[228:231], v[212:215], v[168:171]
  ds_read_b128 v[188:191], v92 offset:53248
  v_mfma_f32_16x16x32_bf16 v[172:175], v[228:231], v[216:219], v[172:175]
  ds_read_b64_tr_b16 v[204:205], v96 offset:16384
  v_mfma_f32_16x16x32_bf16 v[176:179], v[228:231], v[220:223], v[176:179]
  ds_read_b64_tr_b16 v[206:207], v96 offset:16896
  v_mfma_f32_16x16x32_bf16 v[36:39], v[228:231], v[28:31], v[36:39]
  ds_read_b128 v[192:195], v92 offset:55296
  v_mfma_f32_16x16x32_bf16 v[236:239], v[208:211], v[232:235], v[236:239]
  v_mfma_f32_16x16x32_bf16 v[240:243], v[212:215], v[232:235], v[240:243]
  v_mfma_f32_16x16x32_bf16 v[244:247], v[216:219], v[232:235], v[244:247]
  v_mfma_f32_16x16x32_bf16 v[248:251], v[220:223], v[232:235], v[248:251]
  v_mfma_f32_16x16x32_bf16 v[40:43], v[28:31], v[232:235], v[40:43]
  s_waitcnt lgkmcnt(7)
  v_mfma_f32_16x16x32_bf16 v[148:151], v[196:199], v[180:183], v[148:151]
  ds_read_b128 v[208:211], v93 offset:49152
  s_waitcnt lgkmcnt(7)
  v_mfma_f32_16x16x32_bf16 v[152:155], v[196:199], v[184:187], v[152:155]
  ds_read_b64_tr_b16 v[224:225], v96 offset:4096
  s_waitcnt lgkmcnt(5)
  v_mfma_f32_16x16x32_bf16 v[156:159], v[196:199], v[188:191], v[156:159]
  ds_read_b64_tr_b16 v[226:227], v96 offset:4608
  s_waitcnt lgkmcnt(3)
  v_mfma_f32_16x16x32_bf16 v[160:163], v[196:199], v[192:195], v[160:163]
  ds_read_b128 v[212:215], v93 offset:51200
  v_mfma_f32_16x16x32_bf16 v[32:35], v[196:199], v[28:31], v[32:35]
  ds_read_b64_tr_b16 v[228:229], v96 offset:12288
  v_mfma_f32_16x16x32_bf16 v[164:167], v[200:203], v[180:183], v[164:167]
  ds_read_b64_tr_b16 v[230:231], v96 offset:12800
  v_mfma_f32_16x16x32_bf16 v[168:171], v[200:203], v[184:187], v[168:171]
  ds_read_b128 v[216:219], v93 offset:53248
  v_mfma_f32_16x16x32_bf16 v[172:175], v[200:203], v[188:191], v[172:175]
  ds_read_b64_tr_b16 v[232:233], v96 offset:20480
  v_mfma_f32_16x16x32_bf16 v[176:179], v[200:203], v[192:195], v[176:179]
  ds_read_b64_tr_b16 v[234:235], v96 offset:20992
  v_mfma_f32_16x16x32_bf16 v[36:39], v[200:203], v[28:31], v[36:39]
  ds_read_b128 v[220:223], v93 offset:55296
  v_mfma_f32_16x16x32_bf16 v[236:239], v[180:183], v[204:207], v[236:239]
  v_mfma_f32_16x16x32_bf16 v[240:243], v[184:187], v[204:207], v[240:243]
  v_mfma_f32_16x16x32_bf16 v[244:247], v[188:191], v[204:207], v[244:247]
  v_mfma_f32_16x16x32_bf16 v[248:251], v[192:195], v[204:207], v[248:251]
  v_mfma_f32_16x16x32_bf16 v[40:43], v[28:31], v[204:207], v[40:43]
  s_waitcnt lgkmcnt(0)
  s_barrier
  v_mfma_f32_16x16x32_bf16 v[148:151], v[224:227], v[208:211], v[148:151]
  ds_read_b128 v[180:183], v92 offset:57344
  v_mfma_f32_16x16x32_bf16 v[152:155], v[224:227], v[212:215], v[152:155]
  ds_read_b64_tr_b16 v[196:197], v97 offset:0
  v_mfma_f32_16x16x32_bf16 v[156:159], v[224:227], v[216:219], v[156:159]
  ds_read_b64_tr_b16 v[198:199], v97 offset:512
  v_mfma_f32_16x16x32_bf16 v[160:163], v[224:227], v[220:223], v[160:163]
  ds_read_b128 v[184:187], v92 offset:59392
  v_mfma_f32_16x16x32_bf16 v[32:35], v[224:227], v[28:31], v[32:35]
  ds_read_b64_tr_b16 v[200:201], v97 offset:8192
  v_mfma_f32_16x16x32_bf16 v[164:167], v[228:231], v[208:211], v[164:167]
  ds_read_b64_tr_b16 v[202:203], v97 offset:8704
  v_mfma_f32_16x16x32_bf16 v[168:171], v[228:231], v[212:215], v[168:171]
  ds_read_b128 v[188:191], v92 offset:61440
  v_mfma_f32_16x16x32_bf16 v[172:175], v[228:231], v[216:219], v[172:175]
  ds_read_b64_tr_b16 v[204:205], v97 offset:16384
  v_mfma_f32_16x16x32_bf16 v[176:179], v[228:231], v[220:223], v[176:179]
  ds_read_b64_tr_b16 v[206:207], v97 offset:16896
  v_mfma_f32_16x16x32_bf16 v[36:39], v[228:231], v[28:31], v[36:39]
  ds_read_b128 v[192:195], v92 offset:63488
  v_mfma_f32_16x16x32_bf16 v[236:239], v[208:211], v[232:235], v[236:239]
  v_mfma_f32_16x16x32_bf16 v[240:243], v[212:215], v[232:235], v[240:243]
  v_mfma_f32_16x16x32_bf16 v[244:247], v[216:219], v[232:235], v[244:247]
  v_mfma_f32_16x16x32_bf16 v[248:251], v[220:223], v[232:235], v[248:251]
  v_mfma_f32_16x16x32_bf16 v[40:43], v[28:31], v[232:235], v[40:43]
  s_waitcnt lgkmcnt(7)
  v_mfma_f32_16x16x32_bf16 v[148:151], v[196:199], v[180:183], v[148:151]
  ds_read_b128 v[208:211], v93 offset:57344
  s_waitcnt lgkmcnt(7)
  v_mfma_f32_16x16x32_bf16 v[152:155], v[196:199], v[184:187], v[152:155]
  ds_read_b64_tr_b16 v[224:225], v97 offset:4096
  s_waitcnt lgkmcnt(5)
  v_mfma_f32_16x16x32_bf16 v[156:159], v[196:199], v[188:191], v[156:159]
  ds_read_b64_tr_b16 v[226:227], v97 offset:4608
  s_waitcnt lgkmcnt(3)
  v_mfma_f32_16x16x32_bf16 v[160:163], v[196:199], v[192:195], v[160:163]
  ds_read_b128 v[212:215], v93 offset:59392
  v_mfma_f32_16x16x32_bf16 v[32:35], v[196:199], v[28:31], v[32:35]
  ds_read_b64_tr_b16 v[228:229], v97 offset:12288
  v_mfma_f32_16x16x32_bf16 v[164:167], v[200:203], v[180:183], v[164:167]
  ds_read_b64_tr_b16 v[230:231], v97 offset:12800
  v_mfma_f32_16x16x32_bf16 v[168:171], v[200:203], v[184:187], v[168:171]
  ds_read_b128 v[216:219], v93 offset:61440
  v_mfma_f32_16x16x32_bf16 v[172:175], v[200:203], v[188:191], v[172:175]
  ds_read_b64_tr_b16 v[232:233], v97 offset:20480
  v_mfma_f32_16x16x32_bf16 v[176:179], v[200:203], v[192:195], v[176:179]
  ds_read_b64_tr_b16 v[234:235], v97 offset:20992
  v_mfma_f32_16x16x32_bf16 v[36:39], v[200:203], v[28:31], v[36:39]
  ds_read_b128 v[220:223], v93 offset:63488
  v_mfma_f32_16x16x32_bf16 v[236:239], v[180:183], v[204:207], v[236:239]
  v_mfma_f32_16x16x32_bf16 v[240:243], v[184:187], v[204:207], v[240:243]
  v_mfma_f32_16x16x32_bf16 v[244:247], v[188:191], v[204:207], v[244:247]
  v_mfma_f32_16x16x32_bf16 v[248:251], v[192:195], v[204:207], v[248:251]
  v_mfma_f32_16x16x32_bf16 v[40:43], v[28:31], v[204:207], v[40:43]
  s_waitcnt lgkmcnt(7)
  v_mfma_f32_16x16x32_bf16 v[148:151], v[224:227], v[208:211], v[148:151]
  s_waitcnt lgkmcnt(6)
  v_mfma_f32_16x16x32_bf16 v[152:155], v[224:227], v[212:215], v[152:155]
  s_waitcnt lgkmcnt(3)
  v_mfma_f32_16x16x32_bf16 v[156:159], v[224:227], v[216:219], v[156:159]
  s_waitcnt lgkmcnt(0)
  v_mfma_f32_16x16x32_bf16 v[160:163], v[224:227], v[220:223], v[160:163]
  v_mfma_f32_16x16x32_bf16 v[32:35], v[224:227], v[28:31], v[32:35]
  v_mfma_f32_16x16x32_bf16 v[164:167], v[228:231], v[208:211], v[164:167]
  v_mfma_f32_16x16x32_bf16 v[168:171], v[228:231], v[212:215], v[168:171]
  v_mfma_f32_16x16x32_bf16 v[172:175], v[228:231], v[216:219], v[172:175]
  v_mfma_f32_16x16x32_bf16 v[176:179], v[228:231], v[220:223], v[176:179]
  v_mfma_f32_16x16x32_bf16 v[36:39], v[228:231], v[28:31], v[36:39]
  v_mfma_f32_16x16x32_bf16 v[236:239], v[208:211], v[232:235], v[236:239]
  v_mfma_f32_16x16x32_bf16 v[240:243], v[212:215], v[232:235], v[240:243]
  v_mfma_f32_16x16x32_bf16 v[244:247], v[216:219], v[232:235], v[244:247]
  v_mfma_f32_16x16x32_bf16 v[248:251], v[220:223], v[232:235], v[248:251]
  v_mfma_f32_16x16x32_bf16 v[40:43], v[28:31], v[232:235], v[40:43]
  s_cmp_eq_u32 s48, 0
  s_cbranch_scc0 LC_ph_7
  s_waitcnt vmcnt(0)
  s_add_u32 s74, s49, 1
  s_mov_b32 s75, 0
  s_branch LC_pk_10
LC_pl_8:
  buffer_load_dwordx4 v[144:147], v136, s[36:39], 0 offen sc1
  s_waitcnt vmcnt(0)
LC_pk_10:
  v_subrev_u32 v144, s74, v144
  v_subrev_u32 v145, s74, v145
  v_subrev_u32 v146, s74, v146
  v_subrev_u32 v147, s74, v147
  v_max3_u32 v4, v144, v145, v146
  v_max_u32 v4, v4, v147
  v_cmp_ge_u32 vcc, 6, v4
  s_add_u32 s75, s75, 1
  s_nop 2
  s_cmp_eq_u64 vcc, exec
  s_cbranch_scc1 LC_pd_9
  s_cmp_lt_u32 s75, 400000
  s_cbranch_scc1 LC_pl_8
LC_pd_9:
LC_ph_7:
  s_barrier
  ds_read_b32 v180, v106 offset:0
  ds_read_b32 v188, v106 offset:256
  ds_read_b32 v182, v106 offset:64
  ds_read_b32 v190, v106 offset:320
  ds_read_b32 v184, v106 offset:128
  ds_read_b32 v192, v106 offset:384
  ds_read_b32 v186, v106 offset:192
  ds_read_b32 v194, v106 offset:448
  ds_read_b128 v[196:199], v107 offset:0
  ds_read_b128 v[212:215], v107 offset:256
  ds_read_b128 v[200:203], v107 offset:64
  ds_read_b128 v[216:219], v107 offset:320
  ds_read_b128 v[204:207], v107 offset:128
  ds_read_b128 v[220:223], v107 offset:384
  ds_read_b128 v[208:211], v107 offset:192
  ds_read_b128 v[224:227], v107 offset:448
  s_waitcnt lgkmcnt(9)
  v_pk_fma_f32 v[176:177], v[36:37], v[186:187], v[176:177] op_sel_hi:[1,0,1] neg_lo:[0,1,0] neg_hi:[0,1,0]
  v_pk_fma_f32 v[178:179], v[38:39], v[186:187], v[178:179] op_sel_hi:[1,0,1] neg_lo:[0,1,0] neg_hi:[0,1,0]
  s_waitcnt lgkmcnt(8)
  v_pk_mul_f32 v[176:177], v[176:177], v[194:195] op_sel_hi:[1,0]
  v_pk_mul_f32 v[178:179], v[178:179], v[194:195] op_sel_hi:[1,0]
  v_cvt_pk_bf16_f32 v80, v176, v177
  v_cvt_pk_bf16_f32 v81, v178, v179
  v_mov_b32 v4, v40
  s_waitcnt lgkmcnt(1)
  v_pk_fma_f32 v[248:249], v[208:209], v[4:5], v[248:249] op_sel_hi:[1,0,1] neg_lo:[0,1,0] neg_hi:[0,1,0]
  v_pk_fma_f32 v[250:251], v[210:211], v[4:5], v[250:251] op_sel_hi:[1,0,1] neg_lo:[0,1,0] neg_hi:[0,1,0]
  s_waitcnt lgkmcnt(0)
  v_pk_mul_f32 v[248:249], v[248:249], v[224:225]
  v_pk_mul_f32 v[250:251], v[250:251], v[226:227]
  v_cvt_pk_bf16_f32 v90, v248, v249
  v_cvt_pk_bf16_f32 v91, v250, v251
  v_pk_fma_f32 v[160:161], v[32:33], v[186:187], v[160:161] op_sel_hi:[1,0,1] neg_lo:[0,1,0] neg_hi:[0,1,0]
  v_pk_fma_f32 v[162:163], v[34:35], v[186:187], v[162:163] op_sel_hi:[1,0,1] neg_lo:[0,1,0] neg_hi:[0,1,0]
  v_pk_mul_f32 v[160:161], v[160:161], v[194:195] op_sel_hi:[1,0]
  v_pk_mul_f32 v[162:163], v[162:163], v[194:195] op_sel_hi:[1,0]
  v_cvt_pk_bf16_f32 v70, v160, v161
  v_cvt_pk_bf16_f32 v71, v162, v163
  buffer_store_dwordx2 v[80:81], v109, s[36:39], 0 offen sc1
  buffer_store_dwordx2 v[90:91], v109, s[36:39], 0 offen offset:512 sc1
  v_pk_fma_f32 v[164:165], v[36:37], v[180:181], v[164:165] op_sel_hi:[1,0,1] neg_lo:[0,1,0] neg_hi:[0,1,0]
  v_pk_fma_f32 v[166:167], v[38:39], v[180:181], v[166:167] op_sel_hi:[1,0,1] neg_lo:[0,1,0] neg_hi:[0,1,0]
  v_pk_mul_f32 v[164:165], v[164:165], v[188:189] op_sel_hi:[1,0]
  v_pk_mul_f32 v[166:167], v[166:167], v[188:189] op_sel_hi:[1,0]
  v_cvt_pk_bf16_f32 v74, v164, v165
  v_cvt_pk_bf16_f32 v75, v166, v167
  v_mov_b32 v4, v40
  v_pk_fma_f32 v[236:237], v[196:197], v[4:5], v[236:237] op_sel_hi:[1,0,1] neg_lo:[0,1,0] neg_hi:[0,1,0]
  v_pk_fma_f32 v[238:239], v[198:199], v[4:5], v[238:239] op_sel_hi:[1,0,1] neg_lo:[0,1,0] neg_hi:[0,1,0]
  v_pk_mul_f32 v[236:237], v[236:237], v[212:213]
  v_pk_mul_f32 v[238:239], v[238:239], v[214:215]
  v_cvt_pk_bf16_f32 v84, v236, v237
  v_cvt_pk_bf16_f32 v85, v238, v239
  v_pk_fma_f32 v[148:149], v[32:33], v[180:181], v[148:149] op_sel_hi:[1,0,1] neg_lo:[0,1,0] neg_hi:[0,1,0]
  v_pk_fma_f32 v[150:151], v[34:35], v[180:181], v[150:151] op_sel_hi:[1,0,1] neg_lo:[0,1,0] neg_hi:[0,1,0]
  v_pk_mul_f32 v[148:149], v[148:149], v[188:189] op_sel_hi:[1,0]
  v_pk_mul_f32 v[150:151], v[150:151], v[188:189] op_sel_hi:[1,0]
  v_cvt_pk_bf16_f32 v64, v148, v149
  v_cvt_pk_bf16_f32 v65, v150, v151
  v_pk_fma_f32 v[168:169], v[36:37], v[182:183], v[168:169] op_sel_hi:[1,0,1] neg_lo:[0,1,0] neg_hi:[0,1,0]
  v_pk_fma_f32 v[170:171], v[38:39], v[182:183], v[170:171] op_sel_hi:[1,0,1] neg_lo:[0,1,0] neg_hi:[0,1,0]
  v_pk_mul_f32 v[168:169], v[168:169], v[190:191] op_sel_hi:[1,0]
  v_pk_mul_f32 v[170:171], v[170:171], v[190:191] op_sel_hi:[1,0]
  v_cvt_pk_bf16_f32 v76, v168, v169
  v_cvt_pk_bf16_f32 v77, v170, v171
  v_mov_b32 v4, v40
  v_pk_fma_f32 v[240:241], v[200:201], v[4:5], v[240:241] op_sel_hi:[1,0,1] neg_lo:[0,1,0] neg_hi:[0,1,0]
  v_pk_fma_f32 v[242:243], v[202:203], v[4:5], v[242:243] op_sel_hi:[1,0,1] neg_lo:[0,1,0] neg_hi:[0,1,0]
  v_pk_mul_f32 v[240:241], v[240:241], v[216:217]
  v_pk_mul_f32 v[242:243], v[242:243], v[218:219]
  v_cvt_pk_bf16_f32 v86, v240, v241
  v_cvt_pk_bf16_f32 v87, v242, v243
  v_pk_fma_f32 v[152:153], v[32:33], v[182:183], v[152:153] op_sel_hi:[1,0,1] neg_lo:[0,1,0] neg_hi:[0,1,0]
  v_pk_fma_f32 v[154:155], v[34:35], v[182:183], v[154:155] op_sel_hi:[1,0,1] neg_lo:[0,1,0] neg_hi:[0,1,0]
  v_pk_mul_f32 v[152:153], v[152:153], v[190:191] op_sel_hi:[1,0]
  v_pk_mul_f32 v[154:155], v[154:155], v[190:191] op_sel_hi:[1,0]
  v_cvt_pk_bf16_f32 v66, v152, v153
  v_cvt_pk_bf16_f32 v67, v154, v155
  v_pk_fma_f32 v[172:173], v[36:37], v[184:185], v[172:173] op_sel_hi:[1,0,1] neg_lo:[0,1,0] neg_hi:[0,1,0]
  v_pk_fma_f32 v[174:175], v[38:39], v[184:185], v[174:175] op_sel_hi:[1,0,1] neg_lo:[0,1,0] neg_hi:[0,1,0]
  v_pk_mul_f32 v[172:173], v[172:173], v[192:193] op_sel_hi:[1,0]
  v_pk_mul_f32 v[174:175], v[174:175], v[192:193] op_sel_hi:[1,0]
  v_cvt_pk_bf16_f32 v78, v172, v173
  v_cvt_pk_bf16_f32 v79, v174, v175
  v_mov_b32 v4, v40
  v_pk_fma_f32 v[244:245], v[204:205], v[4:5], v[244:245] op_sel_hi:[1,0,1] neg_lo:[0,1,0] neg_hi:[0,1,0]
  v_pk_fma_f32 v[246:247], v[206:207], v[4:5], v[246:247] op_sel_hi:[1,0,1] neg_lo:[0,1,0] neg_hi:[0,1,0]
  v_pk_mul_f32 v[244:245], v[244:245], v[220:221]
  v_pk_mul_f32 v[246:247], v[246:247], v[222:223]
  v_cvt_pk_bf16_f32 v88, v244, v245
  v_cvt_pk_bf16_f32 v89, v246, v247
  v_pk_fma_f32 v[156:157], v[32:33], v[184:185], v[156:157] op_sel_hi:[1,0,1] neg_lo:[0,1,0] neg_hi:[0,1,0]
  v_pk_fma_f32 v[158:159], v[34:35], v[184:185], v[158:159] op_sel_hi:[1,0,1] neg_lo:[0,1,0] neg_hi:[0,1,0]
  v_pk_mul_f32 v[156:157], v[156:157], v[192:193] op_sel_hi:[1,0]
  v_pk_mul_f32 v[158:159], v[158:159], v[192:193] op_sel_hi:[1,0]
  v_cvt_pk_bf16_f32 v68, v156, v157
  v_cvt_pk_bf16_f32 v69, v158, v159
  v_lshlrev_b32 v180, 16, v20
  v_and_b32 v181, 4294901760, v20
  v_lshlrev_b32 v182, 16, v21
  v_and_b32 v183, 4294901760, v21
  v_lshlrev_b32 v184, 16, v22
  v_and_b32 v185, 4294901760, v22
  v_lshlrev_b32 v186, 16, v23
  v_and_b32 v187, 4294901760, v23
  v_lshlrev_b32 v188, 16, v24
  v_and_b32 v189, 4294901760, v24
  v_lshlrev_b32 v190, 16, v25
  v_and_b32 v191, 4294901760, v25
  v_lshlrev_b32 v192, 16, v26
  v_and_b32 v193, 4294901760, v26
  v_lshlrev_b32 v194, 16, v27
  v_and_b32 v195, 4294901760, v27
  v_mul_f32 v4, v16, v18
  v_mov_b32 v8, v18
  v_mul_f32 v6, v17, v19
  v_mov_b32 v10, v19
  v_pk_fma_f32 v[164:165], v[180:181], v[8:9], v[4:5] op_sel_hi:[1,0,0] neg_lo:[0,0,1] neg_hi:[0,0,1]
  v_pk_fma_f32 v[166:167], v[182:183], v[8:9], v[4:5] op_sel_hi:[1,0,0] neg_lo:[0,0,1] neg_hi:[0,0,1]
  v_pk_fma_f32 v[168:169], v[184:185], v[8:9], v[4:5] op_sel_hi:[1,0,0] neg_lo:[0,0,1] neg_hi:[0,0,1]
  v_pk_fma_f32 v[170:171], v[186:187], v[8:9], v[4:5] op_sel_hi:[1,0,0] neg_lo:[0,0,1] neg_hi:[0,0,1]
  v_pk_fma_f32 v[172:173], v[188:189], v[10:11], v[6:7] op_sel_hi:[1,0,0] neg_lo:[0,0,1] neg_hi:[0,0,1]
  v_pk_fma_f32 v[174:175], v[190:191], v[10:11], v[6:7] op_sel_hi:[1,0,0] neg_lo:[0,0,1] neg_hi:[0,0,1]
  v_pk_fma_f32 v[176:177], v[192:193], v[10:11], v[6:7] op_sel_hi:[1,0,0] neg_lo:[0,0,1] neg_hi:[0,0,1]
  v_pk_fma_f32 v[178:179], v[194:195], v[10:11], v[6:7] op_sel_hi:[1,0,0] neg_lo:[0,0,1] neg_hi:[0,0,1]
  v_mov_b32 v148, 0
  v_mov_b32 v149, 0
  v_mov_b32 v150, 0
  v_mov_b32 v151, 0
  v_mov_b32 v152, 0
  v_mov_b32 v153, 0
  v_mov_b32 v154, 0
  v_mov_b32 v155, 0
  v_mov_b32 v156, 0
  v_mov_b32 v157, 0
  v_mov_b32 v158, 0
  v_mov_b32 v159, 0
  v_mov_b32 v160, 0
  v_mov_b32 v161, 0
  v_mov_b32 v162, 0
  v_mov_b32 v163, 0
  s_barrier
  ds_read_b128 v[180:183], v50 offset:0
  ds_read_b64_tr_b16 v[188:189], v54 offset:0
  ds_read_b64_tr_b16 v[190:191], v54 offset:512
  ds_read_b128 v[184:187], v252 offset:0
  ds_read_b64_tr_b16 v[192:193], v55 offset:0
  ds_read_b64_tr_b16 v[194:195], v55 offset:512
  ds_read_b128 v[196:199], v51 offset:0
  ds_read_b64_tr_b16 v[204:205], v54 offset:4096
  ds_read_b64_tr_b16 v[206:207], v54 offset:4608
  ds_read_b128 v[200:203], v253 offset:0
  ds_read_b64_tr_b16 v[208:209], v55 offset:4096
  ds_read_b64_tr_b16 v[210:211], v55 offset:4608
  s_waitcnt lgkmcnt(0)
  s_waitcnt vmcnt(0)
  s_add_u32 s74, s49, 2
  v_mov_b32 v4, s74
  v_mov_b32 v5, s67
  s_mov_b64 exec, 1
  buffer_store_dword v4, v5, s[36:39], 0 offen sc1
  s_mov_b64 exec, -1
  s_barrier
  v_mfma_f32_16x16x32_bf16 v[148:151], v[188:191], v[180:183], v[148:151]
  ds_read_b128 v[212:215], v50 offset:8192
  ds_read_b64_tr_b16 v[220:221], v54 offset:8192
  ds_read_b64_tr_b16 v[222:223], v54 offset:8704
  v_mfma_f32_16x16x32_bf16 v[156:159], v[188:191], v[184:187], v[156:159]
  ds_read_b128 v[216:219], v252 offset:8192
  ds_read_b64_tr_b16 v[224:225], v55 offset:8192
  ds_read_b64_tr_b16 v[226:227], v55 offset:8704
  v_mfma_f32_16x16x32_bf16 v[152:155], v[192:195], v[180:183], v[152:155]
  ds_read_b128 v[228:231], v51 offset:8192
  ds_read_b64_tr_b16 v[236:237], v54 offset:12288
  ds_read_b64_tr_b16 v[238:239], v54 offset:12800
  v_mfma_f32_16x16x32_bf16 v[160:163], v[192:195], v[184:187], v[160:163]
  ds_read_b128 v[232:235], v253 offset:8192
  ds_read_b64_tr_b16 v[240:241], v55 offset:12288
  ds_read_b64_tr_b16 v[242:243], v55 offset:12800
  v_mfma_f32_16x16x32_bf16 v[148:151], v[204:207], v[196:199], v[148:151]
  v_mfma_f32_16x16x32_bf16 v[156:159], v[204:207], v[200:203], v[156:159]
  v_mfma_f32_16x16x32_bf16 v[152:155], v[208:211], v[196:199], v[152:155]
  v_mfma_f32_16x16x32_bf16 v[160:163], v[208:211], v[200:203], v[160:163]
  s_waitcnt lgkmcnt(0)
  s_barrier
  v_mfma_f32_16x16x32_bf16 v[148:151], v[220:223], v[212:215], v[148:151]
  ds_read_b128 v[180:183], v50 offset:16384
  ds_read_b64_tr_b16 v[188:189], v54 offset:16384
  ds_read_b64_tr_b16 v[190:191], v54 offset:16896
  v_mfma_f32_16x16x32_bf16 v[156:159], v[220:223], v[216:219], v[156:159]
  ds_read_b128 v[184:187], v252 offset:16384
  ds_read_b64_tr_b16 v[192:193], v55 offset:16384
  ds_read_b64_tr_b16 v[194:195], v55 offset:16896
  v_mfma_f32_16x16x32_bf16 v[152:155], v[224:227], v[212:215], v[152:155]
  ds_read_b128 v[196:199], v51 offset:16384
  ds_read_b64_tr_b16 v[204:205], v54 offset:20480
  ds_read_b64_tr_b16 v[206:207], v54 offset:20992
  v_mfma_f32_16x16x32_bf16 v[160:163], v[224:227], v[216:219], v[160:163]
  ds_read_b128 v[200:203], v253 offset:16384
  ds_read_b64_tr_b16 v[208:209], v55 offset:20480
  ds_read_b64_tr_b16 v[210:211], v55 offset:20992
  v_mfma_f32_16x16x32_bf16 v[148:151], v[236:239], v[228:231], v[148:151]
  v_mfma_f32_16x16x32_bf16 v[156:159], v[236:239], v[232:235], v[156:159]
  v_mfma_f32_16x16x32_bf16 v[152:155], v[240:243], v[228:231], v[152:155]
  v_mfma_f32_16x16x32_bf16 v[160:163], v[240:243], v[232:235], v[160:163]
  s_waitcnt lgkmcnt(9)
  v_mfma_f32_16x16x32_bf16 v[148:151], v[188:191], v[180:183], v[148:151]
  ds_read_b128 v[212:215], v50 offset:24576
  ds_read_b64_tr_b16 v[220:221], v54 offset:24576
  ds_read_b64_tr_b16 v[222:223], v54 offset:25088
  s_waitcnt lgkmcnt(11)
  v_mfma_f32_16x16x32_bf16 v[156:159], v[188:191], v[184:187], v[156:159]
  ds_read_b128 v[216:219], v252 offset:24576
  ds_read_b64_tr_b16 v[224:225], v55 offset:24576
  ds_read_b64_tr_b16 v[226:227], v55 offset:25088
  s_waitcnt lgkmcnt(12)
  v_mfma_f32_16x16x32_bf16 v[152:155], v[192:195], v[180:183], v[152:155]
  ds_read_b128 v[228:231], v51 offset:24576
  ds_read_b64_tr_b16 v[236:237], v54 offset:28672
  ds_read_b64_tr_b16 v[238:239], v54 offset:29184
  v_mfma_f32_16x16x32_bf16 v[160:163], v[192:195], v[184:187], v[160:163]
  ds_read_b128 v[232:235], v253 offset:24576
  ds_read_b64_tr_b16 v[240:241], v55 offset:28672
  ds_read_b64_tr_b16 v[242:243], v55 offset:29184
  s_waitcnt lgkmcnt(15)
  v_mfma_f32_16x16x32_bf16 v[148:151], v[204:207], v[196:199], v[148:151]
  s_waitcnt lgkmcnt(14)
  v_mfma_f32_16x16x32_bf16 v[156:159], v[204:207], v[200:203], v[156:159]
  s_waitcnt lgkmcnt(12)
  v_mfma_f32_16x16x32_bf16 v[152:155], v[208:211], v[196:199], v[152:155]
  v_mfma_f32_16x16x32_bf16 v[160:163], v[208:211], v[200:203], v[160:163]
  s_waitcnt lgkmcnt(0)
  s_barrier
  v_mfma_f32_16x16x32_bf16 v[148:151], v[220:223], v[212:215], v[148:151]
  ds_read_b128 v[180:183], v50 offset:32768
  ds_read_b64_tr_b16 v[188:189], v54 offset:32768
  ds_read_b64_tr_b16 v[190:191], v54 offset:33280
  v_mfma_f32_16x16x32_bf16 v[156:159], v[220:223], v[216:219], v[156:159]
  ds_read_b128 v[184:187], v252 offset:32768
  ds_read_b64_tr_b16 v[192:193], v55 offset:32768
  ds_read_b64_tr_b16 v[194:195], v55 offset:33280
  v_mfma_f32_16x16x32_bf16 v[152:155], v[224:227], v[212:215], v[152:155]
  ds_read_b128 v[196:199], v51 offset:32768
  ds_read_b64_tr_b16 v[204:205], v54 offset:36864
  ds_read_b64_tr_b16 v[206:207], v54 offset:37376
  v_mfma_f32_16x16x32_bf16 v[160:163], v[224:227], v[216:219], v[160:163]
  ds_read_b128 v[200:203], v253 offset:32768
  ds_read_b64_tr_b16 v[208:209], v55 offset:36864
  ds_read_b64_tr_b16 v[210:211], v55 offset:37376
  v_mfma_f32_16x16x32_bf16 v[148:151], v[236:239], v[228:231], v[148:151]
  v_mfma_f32_16x16x32_bf16 v[156:159], v[236:239], v[232:235], v[156:159]
  v_mfma_f32_16x16x32_bf16 v[152:155], v[240:243], v[228:231], v[152:155]
  v_mfma_f32_16x16x32_bf16 v[160:163], v[240:243], v[232:235], v[160:163]
  s_waitcnt lgkmcnt(9)
  v_mfma_f32_16x16x32_bf16 v[148:151], v[188:191], v[180:183], v[148:151]
  ds_read_b128 v[212:215], v50 offset:40960
  ds_read_b64_tr_b16 v[220:221], v54 offset:40960
  ds_read_b64_tr_b16 v[222:223], v54 offset:41472
  s_waitcnt lgkmcnt(11)
  v_mfma_f32_16x16x32_bf16 v[156:159], v[188:191], v[184:187], v[156:159]
  ds_read_b128 v[216:219], v252 offset:40960
  ds_read_b64_tr_b16 v[224:225], v55 offset:40960
  ds_read_b64_tr_b16 v[226:227], v55 offset:41472
  s_waitcnt lgkmcnt(12)
  v_mfma_f32_16x16x32_bf16 v[152:155], v[192:195], v[180:183], v[152:155]
  ds_read_b128 v[228:231], v51 offset:40960
  ds_read_b64_tr_b16 v[236:237], v54 offset:45056
  ds_read_b64_tr_b16 v[238:239], v54 offset:45568
  v_mfma_f32_16x16x32_bf16 v[160:163], v[192:195], v[184:187], v[160:163]
  ds_read_b128 v[232:235], v253 offset:40960
  ds_read_b64_tr_b16 v[240:241], v55 offset:45056
  ds_read_b64_tr_b16 v[242:243], v55 offset:45568
  s_waitcnt lgkmcnt(15)
  v_mfma_f32_16x16x32_bf16 v[148:151], v[204:207], v[196:199], v[148:151]
  s_waitcnt lgkmcnt(14)
  v_mfma_f32_16x16x32_bf16 v[156:159], v[204:207], v[200:203], v[156:159]
  s_waitcnt lgkmcnt(12)
  v_mfma_f32_16x16x32_bf16 v[152:155], v[208:211], v[196:199], v[152:155]
  v_mfma_f32_16x16x32_bf16 v[160:163], v[208:211], v[200:203], v[160:163]
  s_waitcnt lgkmcnt(0)
  s_barrier
  buffer_load_dword v144, v111, s[36:39], 0 offen sc1
  v_mfma_f32_16x16x32_bf16 v[148:151], v[220:223], v[212:215], v[148:151]
  ds_read_b128 v[180:183], v50 offset:49152
  ds_read_b64_tr_b16 v[188:189], v54 offset:49152
  ds_read_b64_tr_b16 v[190:191], v54 offset:49664
  v_mfma_f32_16x16x32_bf16 v[156:159], v[220:223], v[216:219], v[156:159]
  ds_read_b128 v[184:187], v252 offset:49152
  ds_read_b64_tr_b16 v[192:193], v55 offset:49152
  ds_read_b64_tr_b16 v[194:195], v55 offset:49664
  v_mfma_f32_16x16x32_bf16 v[152:155], v[224:227], v[212:215], v[152:155]
  ds_read_b128 v[196:199], v51 offset:49152
  ds_read_b64_tr_b16 v[204:205], v54 offset:53248
  ds_read_b64_tr_b16 v[206:207], v54 offset:53760
  v_mfma_f32_16x16x32_bf16 v[160:163], v[224:227], v[216:219], v[160:163]
  ds_read_b128 v[200:203], v253 offset:49152
  ds_read_b64_tr_b16 v[208:209], v55 offset:53248
  ds_read_b64_tr_b16 v[210:211], v55 offset:53760
  v_mfma_f32_16x16x32_bf16 v[148:151], v[236:239], v[228:231], v[148:151]
  v_mfma_f32_16x16x32_bf16 v[156:159], v[236:239], v[232:235], v[156:159]
  v_mfma_f32_16x16x32_bf16 v[152:155], v[240:243], v[228:231], v[152:155]
  v_mfma_f32_16x16x32_bf16 v[160:163], v[240:243], v[232:235], v[160:163]
  s_waitcnt lgkmcnt(9)
  v_mfma_f32_16x16x32_bf16 v[148:151], v[188:191], v[180:183], v[148:151]
  ds_read_b128 v[212:215], v50 offset:57344
  ds_read_b64_tr_b16 v[220:221], v54 offset:57344
  ds_read_b64_tr_b16 v[222:223], v54 offset:57856
  s_waitcnt lgkmcnt(11)
  v_mfma_f32_16x16x32_bf16 v[156:159], v[188:191], v[184:187], v[156:159]
  ds_read_b128 v[216:219], v252 offset:57344
  ds_read_b64_tr_b16 v[224:225], v55 offset:57344
  ds_read_b64_tr_b16 v[226:227], v55 offset:57856
  s_waitcnt lgkmcnt(12)
  v_mfma_f32_16x16x32_bf16 v[152:155], v[192:195], v[180:183], v[152:155]
  ds_read_b128 v[228:231], v51 offset:57344
  ds_read_b64_tr_b16 v[236:237], v54 offset:61440
  ds_read_b64_tr_b16 v[238:239], v54 offset:61952
  v_mfma_f32_16x16x32_bf16 v[160:163], v[192:195], v[184:187], v[160:163]
  ds_read_b128 v[232:235], v253 offset:57344
  ds_read_b64_tr_b16 v[240:241], v55 offset:61440
  ds_read_b64_tr_b16 v[242:243], v55 offset:61952
  s_waitcnt lgkmcnt(15)
  v_mfma_f32_16x16x32_bf16 v[148:151], v[204:207], v[196:199], v[148:151]
  s_waitcnt lgkmcnt(14)
  v_mfma_f32_16x16x32_bf16 v[156:159], v[204:207], v[200:203], v[156:159]
  s_waitcnt lgkmcnt(12)
  v_mfma_f32_16x16x32_bf16 v[152:155], v[208:211], v[196:199], v[152:155]
  v_mfma_f32_16x16x32_bf16 v[160:163], v[208:211], v[200:203], v[160:163]
  s_waitcnt lgkmcnt(9)
  v_mfma_f32_16x16x32_bf16 v[148:151], v[220:223], v[212:215], v[148:151]
  s_waitcnt lgkmcnt(8)
  v_mfma_f32_16x16x32_bf16 v[156:159], v[220:223], v[216:219], v[156:159]
  s_waitcnt lgkmcnt(6)
  v_mfma_f32_16x16x32_bf16 v[152:155], v[224:227], v[212:215], v[152:155]
  v_mfma_f32_16x16x32_bf16 v[160:163], v[224:227], v[216:219], v[160:163]
  s_waitcnt lgkmcnt(3)
  v_mfma_f32_16x16x32_bf16 v[148:151], v[236:239], v[228:231], v[148:151]
  s_waitcnt lgkmcnt(2)
  v_mfma_f32_16x16x32_bf16 v[156:159], v[236:239], v[232:235], v[156:159]
  s_waitcnt lgkmcnt(0)
  v_mfma_f32_16x16x32_bf16 v[152:155], v[240:243], v[228:231], v[152:155]
  v_mfma_f32_16x16x32_bf16 v[160:163], v[240:243], v[232:235], v[160:163]
  s_barrier
  s_nop 1
  v_pk_add_f32 v[148:149], v[148:149], v[164:165]
  v_pk_add_f32 v[150:151], v[150:151], v[166:167]
  s_nop 1
  v_pk_add_f32 v[152:153], v[152:153], v[168:169]
  v_pk_add_f32 v[154:155], v[154:155], v[170:171]
  v_pk_add_f32 v[156:157], v[156:157], v[172:173]
  v_pk_add_f32 v[158:159], v[158:159], v[174:175]
  v_pk_add_f32 v[160:161], v[160:161], v[176:177]
  v_pk_add_f32 v[162:163], v[162:163], v[178:179]
  v_cvt_pk_bf16_f32 v212, v148, v149
  v_cvt_pk_bf16_f32 v213, v150, v151
  v_cvt_pk_bf16_f32 v214, v152, v153
  v_cvt_pk_bf16_f32 v215, v154, v155
  v_cvt_pk_bf16_f32 v216, v156, v157
  v_cvt_pk_bf16_f32 v217, v158, v159
  v_cvt_pk_bf16_f32 v218, v160, v161
  v_cvt_pk_bf16_f32 v219, v162, v163
  v_permlane16_swap_b32 v212, v214
  v_permlane16_swap_b32 v213, v215
  buffer_store_dwordx4 v[212:215], v94, s[36:39], s62 offen sc1
  v_permlane16_swap_b32 v216, v218
  v_permlane16_swap_b32 v217, v219
  buffer_store_dwordx4 v[216:219], v95, s[36:39], s62 offen sc1
  v_lshlrev_b32 v164, 16, v212
  v_and_b32 v165, 4294901760, v212
  v_lshlrev_b32 v166, 16, v213
  v_and_b32 v167, 4294901760, v213
  v_lshlrev_b32 v168, 16, v214
  v_and_b32 v169, 4294901760, v214
  v_lshlrev_b32 v170, 16, v215
  v_and_b32 v171, 4294901760, v215
  v_lshlrev_b32 v172, 16, v216
  v_and_b32 v173, 4294901760, v216
  v_lshlrev_b32 v174, 16, v217
  v_and_b32 v175, 4294901760, v217
  v_lshlrev_b32 v176, 16, v218
  v_and_b32 v177, 4294901760, v218
  v_lshlrev_b32 v178, 16, v219
  v_and_b32 v179, 4294901760, v219
  v_pk_add_f32 v[4:5], v[164:165], v[166:167]
  v_pk_add_f32 v[6:7], v[168:169], v[170:171]
  v_pk_mul_f32 v[8:9], v[164:165], v[164:165]
  v_pk_fma_f32 v[8:9], v[166:167], v[166:167], v[8:9]
  v_pk_fma_f32 v[8:9], v[168:169], v[168:169], v[8:9]
  v_pk_fma_f32 v[8:9], v[170:171], v[170:171], v[8:9]
  v_pk_add_f32 v[4:5], v[4:5], v[6:7]
  v_add_f32 v220, v4, v5
  v_add_f32 v221, v8, v9
  v_pk_add_f32 v[4:5], v[172:173], v[174:175]
  v_pk_add_f32 v[6:7], v[176:177], v[178:179]
  v_pk_mul_f32 v[8:9], v[172:173], v[172:173]
  v_pk_fma_f32 v[8:9], v[174:175], v[174:175], v[8:9]
  v_pk_fma_f32 v[8:9], v[176:177], v[176:177], v[8:9]
  v_pk_fma_f32 v[8:9], v[178:179], v[178:179], v[8:9]
  v_pk_add_f32 v[4:5], v[4:5], v[6:7]
  v_add_f32 v222, v4, v5
  v_add_f32 v223, v8, v9
  v_mov_b32 v4, v220
  v_mov_b32 v5, v221
  s_nop 0
  v_permlane16_swap_b32 v220, v4
  v_permlane16_swap_b32 v221, v5
  v_add_f32 v220, v220, v4
  v_add_f32 v221, v221, v5
  v_mov_b32 v4, v220
  v_mov_b32 v5, v221
  s_nop 0
  v_permlane32_swap_b32 v220, v4
  v_permlane32_swap_b32 v221, v5
  v_add_f32 v220, v220, v4
  v_add_f32 v221, v221, v5
  v_mov_b32 v4, v222
  v_mov_b32 v5, v223
  s_nop 0
  v_permlane16_swap_b32 v222, v4
  v_permlane16_swap_b32 v223, v5
  v_add_f32 v222, v222, v4
  v_add_f32 v223, v223, v5
  v_mov_b32 v4, v222
  v_mov_b32 v5, v223
  s_nop 0
  v_permlane32_swap_b32 v222, v4
  v_permlane32_swap_b32 v223, v5
  v_add_f32 v222, v222, v4
  v_add_f32 v223, v223, v5
  v_cmp_eq_u32 vcc, 1, v3
  s_nop 1
  v_cndmask_b32 v4, v220, v222, vcc
  v_cndmask_b32 v5, v221, v223, vcc
  s_mov_b64 exec, s[60:61]
  buffer_store_dwordx2 v[4:5], v112, s[36:39], 0 offen sc1
  s_mov_b64 exec, -1
  s_barrier
  v_lshlrev_b32 v180, 16, v20
  v_and_b32 v181, 4294901760, v20
  v_lshlrev_b32 v182, 16, v21
  v_and_b32 v183, 4294901760, v21
  v_lshlrev_b32 v184, 16, v22
  v_and_b32 v185, 4294901760, v22
  v_lshlrev_b32 v186, 16, v23
  v_and_b32 v187, 4294901760, v23
  v_lshlrev_b32 v188, 16, v24
  v_and_b32 v189, 4294901760, v24
  v_lshlrev_b32 v190, 16, v25
  v_and_b32 v191, 4294901760, v25
  v_lshlrev_b32 v192, 16, v26
  v_and_b32 v193, 4294901760, v26
  v_lshlrev_b32 v194, 16, v27
  v_and_b32 v195, 4294901760, v27
  v_pk_add_f32 v[32:33], v[180:181], v[148:149]
  v_pk_add_f32 v[34:35], v[182:183], v[150:151]
  v_pk_add_f32 v[36:37], v[184:185], v[152:153]
  v_pk_add_f32 v[38:39], v[186:187], v[154:155]
  v_pk_add_f32 v[40:41], v[188:189], v[156:157]
  v_pk_add_f32 v[42:43], v[190:191], v[158:159]
  v_pk_add_f32 v[44:45], v[192:193], v[160:161]
  v_pk_add_f32 v[46:47], v[194:195], v[162:163]
  s_add_u32 s74, s49, 2
  s_mov_b32 s75, 0
  s_waitcnt vmcnt(3)
  s_branch LC_hk_13
LC_hl_11:
  buffer_load_dword v144, v111, s[36:39], 0 offen sc1
  s_waitcnt vmcnt(0)
LC_hk_13:
  v_subrev_u32 v4, s74, v144
  v_cmp_ge_u32 vcc, 5, v4
  s_add_u32 s75, s75, 1
  s_nop 2
  s_cmp_eq_u64 vcc, exec
  s_cbranch_scc1 LC_hd_12
  s_cmp_lt_u32 s75, 400000
  s_cbranch_scc1 LC_hl_11
LC_hd_12:
  buffer_load_dwordx2 v[72:73], v110, s[36:39], 0 offen sc1
  buffer_load_dwordx2 v[82:83], v110, s[36:39], 0 offen offset:512 sc1
  v_mfma_f32_16x16x16_bf16 v[180:183], v[78:79], v[70:71], 0
  v_mfma_f32_16x16x16_bf16 v[184:187], v[80:81], v[70:71], 0
  v_mfma_f32_16x16x16_bf16 v[188:191], v[76:77], v[68:69], 0
  v_mfma_f32_16x16x16_bf16 v[192:195], v[78:79], v[68:69], 0
  v_mfma_f32_16x16x16_bf16 v[196:199], v[74:75], v[66:67], 0
  v_mfma_f32_16x16x16_bf16 v[200:203], v[76:77], v[66:67], 0
  s_nop 2
  v_pk_fma_f32 v[180:181], v[180:181], s[80:81], v[114:115]
  v_pk_fma_f32 v[184:185], v[184:185], s[80:81], v[118:119]
  v_pk_fma_f32 v[182:183], v[182:183], s[80:81], v[116:117]
  v_pk_fma_f32 v[186:187], v[186:187], s[80:81], v[120:121]
  v_pk_fma_f32 v[188:189], v[188:189], s[80:81], v[114:115]
  v_pk_fma_f32 v[192:193], v[192:193], s[80:81], v[118:119]
  v_pk_fma_f32 v[190:191], v[190:191], s[80:81], v[116:117]
  v_pk_fma_f32 v[194:195], v[194:195], s[80:81], v[120:121]
  v_pk_fma_f32 v[196:197], v[196:197], s[80:81], v[114:115]
  v_pk_fma_f32 v[200:201], v[200:201], s[80:81], v[118:119]
  v_pk_fma_f32 v[198:199], v[198:199], s[80:81], v[116:117]
  v_pk_fma_f32 v[202:203], v[202:203], s[80:81], v[120:121]
  v_max3_f32 v212, v180, v181, v182
  v_max3_f32 v213, v183, v184, v185
  v_max3_f32 v212, v212, v186, v187
  v_max_f32 v212, v212, v213
  v_max3_f32 v214, v188, v189, v190
  v_max3_f32 v215, v191, v192, v193
  v_max3_f32 v214, v214, v194, v195
  v_max_f32 v214, v214, v215
  v_max3_f32 v216, v196, v197, v198
  v_max3_f32 v217, v199, v200, v201
  v_max3_f32 v216, v216, v202, v203
  v_max_f32 v216, v216, v217
  v_mov_b32 v4, v212
  v_mov_b32 v5, v214
  s_nop 0
  v_permlane16_swap_b32 v212, v4
  v_permlane16_swap_b32 v214, v5
  v_max_f32 v212, v212, v4
  v_max_f32 v214, v214, v5
  v_mov_b32 v4, v212
  v_mov_b32 v5, v214
  s_nop 0
  v_permlane32_swap_b32 v212, v4
  v_permlane32_swap_b32 v214, v5
  v_max_f32 v212, v212, v4
  v_max_f32 v214, v214, v5
  v_mov_b32 v4, v216
  v_mov_b32 v5, v217
  s_nop 0
  v_permlane16_swap_b32 v216, v4
  v_permlane16_swap_b32 v217, v5
  v_max_f32 v216, v216, v4
  v_max_f32 v217, v217, v5
  v_mov_b32 v4, v216
  v_mov_b32 v5, v217
  s_nop 0
  v_permlane32_swap_b32 v216, v4
  v_permlane32_swap_b32 v217, v5
  v_max_f32 v216, v216, v4
  v_max_f32 v217, v217, v5
  v_pk_add_f32 v[180:181], v[180:181], v[212:213] op_sel_hi:[1,0] neg_lo:[0,1] neg_hi:[0,1]
  v_pk_add_f32 v[182:183], v[182:183], v[212:213] op_sel_hi:[1,0] neg_lo:[0,1] neg_hi:[0,1]
  v_pk_add_f32 v[184:185], v[184:185], v[212:213] op_sel_hi:[1,0] neg_lo:[0,1] neg_hi:[0,1]
  v_pk_add_f32 v[186:187], v[186:187], v[212:213] op_sel_hi:[1,0] neg_lo:[0,1] neg_hi:[0,1]
  v_pk_add_f32 v[188:189], v[188:189], v[214:215] op_sel_hi:[1,0] neg_lo:[0,1] neg_hi:[0,1]
  v_pk_add_f32 v[190:191], v[190:191], v[214:215] op_sel_hi:[1,0] neg_lo:[0,1] neg_hi:[0,1]
  v_pk_add_f32 v[192:193], v[192:193], v[214:215] op_sel_hi:[1,0] neg_lo:[0,1] neg_hi:[0,1]
  v_pk_add_f32 v[194:195], v[194:195], v[214:215] op_sel_hi:[1,0] neg_lo:[0,1] neg_hi:[0,1]
  v_pk_add_f32 v[196:197], v[196:197], v[216:217] op_sel_hi:[1,0] neg_lo:[0,1] neg_hi:[0,1]
  v_pk_add_f32 v[198:199], v[198:199], v[216:217] op_sel_hi:[1,0] neg_lo:[0,1] neg_hi:[0,1]
  v_pk_add_f32 v[200:201], v[200:201], v[216:217] op_sel_hi:[1,0] neg_lo:[0,1] neg_hi:[0,1]
  v_pk_add_f32 v[202:203], v[202:203], v[216:217] op_sel_hi:[1,0] neg_lo:[0,1] neg_hi:[0,1]
  v_exp_f32 v180, v180
  v_exp_f32 v181, v181
  v_exp_f32 v182, v182
  v_exp_f32 v183, v183
  v_exp_f32 v184, v184
  v_exp_f32 v185, v185
  v_exp_f32 v186, v186
  v_exp_f32 v187, v187
  v_exp_f32 v188, v188
  v_exp_f32 v189, v189
  v_exp_f32 v190, v190
  v_exp_f32 v191, v191
  v_exp_f32 v192, v192
  v_exp_f32 v193, v193
  v_exp_f32 v194, v194
  v_exp_f32 v195, v195
  v_exp_f32 v196, v196
  v_exp_f32 v197, v197
  v_exp_f32 v198, v198
  v_exp_f32 v199, v199
  v_exp_f32 v200, v200
  v_exp_f32 v201, v201
  v_exp_f32 v202, v202
  v_exp_f32 v203, v203
  v_cvt_pk_bf16_f32 v220, v180, v181
  v_cvt_pk_bf16_f32 v221, v182, v183
  v_cvt_pk_bf16_f32 v222, v184, v185
  v_cvt_pk_bf16_f32 v223, v186, v187
  v_cvt_pk_bf16_f32 v224, v188, v189
  v_cvt_pk_bf16_f32 v225, v190, v191
  v_cvt_pk_bf16_f32 v226, v192, v193
  v_cvt_pk_bf16_f32 v227, v194, v195
  v_cvt_pk_bf16_f32 v228, v196, v197
  v_cvt_pk_bf16_f32 v229, v198, v199
  v_cvt_pk_bf16_f32 v230, v200, v201
  v_cvt_pk_bf16_f32 v231, v202, v203
  v_mfma_f32_16x16x32_bf16 v[164:167], v[28:31], v[220:223], 0
  v_mfma_f32_16x16x32_bf16 v[148:151], v[88:91], v[220:223], 0
  v_mfma_f32_16x16x32_bf16 v[168:171], v[28:31], v[224:227], 0
  v_mfma_f32_16x16x32_bf16 v[152:155], v[86:89], v[224:227], 0
  v_mfma_f32_16x16x32_bf16 v[172:175], v[28:31], v[228:231], 0
  v_mfma_f32_16x16x32_bf16 v[156:159], v[84:87], v[228:231], 0
  s_nop 2
  v_rcp_f32 v164, v164
  s_nop 0
  v_rcp_f32 v168, v168
  s_nop 0
  v_rcp_f32 v172, v172
  v_pk_mul_f32 v[148:149], v[148:149], v[164:165] op_sel_hi:[1,0]
  v_pk_mul_f32 v[150:151], v[150:151], v[164:165] op_sel_hi:[1,0]
  v_pk_mul_f32 v[152:153], v[152:153], v[168:169] op_sel_hi:[1,0]
  v_pk_mul_f32 v[154:155], v[154:155], v[168:169] op_sel_hi:[1,0]
  v_pk_mul_f32 v[156:157], v[156:157], v[172:173] op_sel_hi:[1,0]
  v_pk_mul_f32 v[158:159], v[158:159], v[172:173] op_sel_hi:[1,0]
  v_cvt_pk_bf16_f32 v220, v148, v149
  v_cvt_pk_bf16_f32 v221, v150, v151
  ds_write_b64 v113, v[220:221] offset:6144
  v_cvt_pk_bf16_f32 v224, v152, v153
  v_cvt_pk_bf16_f32 v225, v154, v155
  ds_write_b64 v113, v[224:225] offset:4096
  v_cvt_pk_bf16_f32 v228, v156, v157
  v_cvt_pk_bf16_f32 v229, v158, v159
  ds_write_b64 v113, v[228:229] offset:2048
  s_waitcnt vmcnt(2)
  s_add_u32 s74, s49, 3
  v_mov_b32 v4, s74
  v_mov_b32 v5, s67
  s_mov_b64 exec, 1
  buffer_store_dword v4, v5, s[36:39], 0 offen sc1
  s_mov_b64 exec, -1
  s_waitcnt vmcnt(1)
  v_mfma_f32_16x16x16_bf16 v[180:183], v[72:73], v[64:65], 0
  v_mfma_f32_16x16x16_bf16 v[184:187], v[74:75], v[64:65], 0
  s_nop 6
  v_pk_fma_f32 v[180:181], v[180:181], s[80:81], v[122:123]
  v_pk_fma_f32 v[184:185], v[184:185], s[80:81], v[118:119]
  v_pk_fma_f32 v[182:183], v[182:183], s[80:81], v[124:125]
  v_pk_fma_f32 v[186:187], v[186:187], s[80:81], v[120:121]
  v_max3_f32 v212, v180, v181, v182
  v_max3_f32 v213, v183, v184, v185
  v_max3_f32 v212, v212, v186, v187
  v_max_f32 v212, v212, v213
  v_mov_b32 v4, v212
  v_mov_b32 v5, v213
  s_nop 0
  v_permlane16_swap_b32 v212, v4
  v_permlane16_swap_b32 v213, v5
  v_max_f32 v212, v212, v4
  v_max_f32 v213, v213, v5
  v_mov_b32 v4, v212
  v_mov_b32 v5, v213
  s_nop 0
  v_permlane32_swap_b32 v212, v4
  v_permlane32_swap_b32 v213, v5
  v_max_f32 v212, v212, v4
  v_max_f32 v213, v213, v5
  v_pk_add_f32 v[180:181], v[180:181], v[212:213] op_sel_hi:[1,0] neg_lo:[0,1] neg_hi:[0,1]
  v_pk_add_f32 v[182:183], v[182:183], v[212:213] op_sel_hi:[1,0] neg_lo:[0,1] neg_hi:[0,1]
  v_pk_add_f32 v[184:185], v[184:185], v[212:213] op_sel_hi:[1,0] neg_lo:[0,1] neg_hi:[0,1]
  v_pk_add_f32 v[186:187], v[186:187], v[212:213] op_sel_hi:[1,0] neg_lo:[0,1] neg_hi:[0,1]
  v_exp_f32 v180, v180
  v_exp_f32 v181, v181
  v_exp_f32 v182, v182
  v_exp_f32 v183, v183
  v_exp_f32 v184, v184
  v_exp_f32 v185, v185
  v_exp_f32 v186, v186
  v_exp_f32 v187, v187
  v_cvt_pk_bf16_f32 v220, v180, v181
  v_cvt_pk_bf16_f32 v221, v182, v183
  v_cvt_pk_bf16_f32 v222, v184, v185
  v_cvt_pk_bf16_f32 v223, v186, v187
  s_nop 1
  v_mfma_f32_16x16x32_bf16 v[164:167], v[28:31], v[220:223], 0
  s_waitcnt vmcnt(0)
  v_mfma_f32_16x16x32_bf16 v[148:151], v[82:85], v[220:223], 0
  s_nop 5
  v_rcp_f32 v164, v164
  s_nop 0
  v_pk_mul_f32 v[148:149], v[148:149], v[164:165] op_sel_hi:[1,0]
  v_pk_mul_f32 v[150:151], v[150:151], v[164:165] op_sel_hi:[1,0]
  v_cvt_pk_bf16_f32 v220, v148, v149
  v_cvt_pk_bf16_f32 v221, v150, v151
  ds_write_b64 v113, v[220:221] offset:0
  s_waitcnt lgkmcnt(0)
  s_barrier
  v_mov_b32 v64, 0
  v_mov_b32 v65, 0
  v_mov_b32 v66, 0
  v_mov_b32 v67, 0
  v_mov_b32 v68, 0
  v_mov_b32 v69, 0
  v_mov_b32 v70, 0
  v_mov_b32 v71, 0
  v_mov_b32 v72, 0
  v_mov_b32 v73, 0
  v_mov_b32 v74, 0
  v_mov_b32 v75, 0
  v_mov_b32 v76, 0
  v_mov_b32 v77, 0
  v_mov_b32 v78, 0
  v_mov_b32 v79, 0
  v_mov_b32 v80, 0
  v_mov_b32 v81, 0
  v_mov_b32 v82, 0
  v_mov_b32 v83, 0
  v_mov_b32 v84, 0
  v_mov_b32 v85, 0
  v_mov_b32 v86, 0
  v_mov_b32 v87, 0
  v_mov_b32 v88, 0
  v_mov_b32 v89, 0
  v_mov_b32 v90, 0
  v_mov_b32 v91, 0
  v_mov_b32 v92, 0
  v_mov_b32 v93, 0
  v_mov_b32 v94, 0
  v_mov_b32 v95, 0
  v_mov_b32 v96, 0
  v_mov_b32 v97, 0
  v_mov_b32 v98, 0
  v_mov_b32 v99, 0
  v_mov_b32 v100, 0
  v_mov_b32 v101, 0
  v_mov_b32 v102, 0
  v_mov_b32 v103, 0
  v_mov_b32 v104, 0
  v_mov_b32 v105, 0
  v_mov_b32 v106, 0
  v_mov_b32 v107, 0
  v_mov_b32 v108, 0
  v_mov_b32 v109, 0
  v_mov_b32 v110, 0
  v_mov_b32 v111, 0
  s_mul_i32 s74, s45, 192
  s_add_u32 s74, s74, 147456
  v_lshlrev_b32 v7, 4, v3
  v_add_u32 v7, s74, v7
  s_cmp_eq_u32 s48, 0
  s_cbranch_scc0 LC_px_14
  s_add_u32 s74, s49, 3
  s_mov_b32 s75, 0
LC_pl_15:
  buffer_load_dwordx4 v[144:147], v137, s[36:39], 0 offen sc1
  s_waitcnt vmcnt(0)
LC_pk_17:
  v_subrev_u32 v144, s74, v144
  v_subrev_u32 v145, s74, v145
  v_subrev_u32 v146, s74, v146
  v_subrev_u32 v147, s74, v147
  v_max3_u32 v4, v144, v145, v146
  v_max_u32 v4, v4, v147
  v_cmp_ge_u32 vcc, 4, v4
  s_add_u32 s75, s75, 1
  s_nop 2
  s_cmp_eq_u64 vcc, exec
  s_cbranch_scc1 LC_pd_16
  s_cmp_lt_u32 s75, 400000
  s_cbranch_scc1 LC_pl_15
LC_pd_16:
LC_px_14:
  s_barrier
  s_cmp_eq_u32 s91, 15
  s_cbranch_scc1 LC_p3skip_18
  ds_read_b128 v[180:183], v7 offset:0
  ds_read_b128 v[184:187], v7 offset:64
  ds_read_b128 v[188:191], v7 offset:128
  ds_read_b128 v[192:195], v7 offset:384
  ds_read_b128 v[196:199], v7 offset:448
  ds_read_b128 v[200:203], v7 offset:512
  ds_read_b128 v[204:207], v7 offset:768
  ds_read_b128 v[208:211], v7 offset:832
  ds_read_b128 v[212:215], v7 offset:896
  ds_read_b128 v[216:219], v7 offset:1152
  ds_read_b128 v[220:223], v7 offset:1216
  ds_read_b128 v[224:227], v7 offset:1280
  s_waitcnt lgkmcnt(8)
  v_pk_add_f32 v[180:181], v[180:181], v[192:193]
  v_pk_add_f32 v[182:183], v[182:183], v[194:195]
  s_waitcnt lgkmcnt(7)
  v_pk_add_f32 v[184:185], v[184:185], v[196:197]
  v_pk_add_f32 v[186:187], v[186:187], v[198:199]
  s_waitcnt lgkmcnt(6)
  v_pk_add_f32 v[188:189], v[188:189], v[200:201]
  v_pk_add_f32 v[190:191], v[190:191], v[202:203]
  s_waitcnt lgkmcnt(2)
  v_pk_add_f32 v[204:205], v[204:205], v[216:217]
  v_pk_add_f32 v[206:207], v[206:207], v[218:219]
  s_waitcnt lgkmcnt(1)
  v_pk_add_f32 v[208:209], v[208:209], v[220:221]
  v_pk_add_f32 v[210:211], v[210:211], v[222:223]
  s_waitcnt lgkmcnt(0)
  v_pk_add_f32 v[212:213], v[212:213], v[224:225]
  v_pk_add_f32 v[214:215], v[214:215], v[226:227]
  v_pk_add_f32 v[112:113], v[180:181], v[204:205]
  v_pk_add_f32 v[114:115], v[182:183], v[206:207]
  v_pk_add_f32 v[116:117], v[184:185], v[208:209]
  v_pk_add_f32 v[118:119], v[186:187], v[210:211]
  v_pk_add_f32 v[120:121], v[188:189], v[212:213]
  v_pk_add_f32 v[122:123], v[190:191], v[214:215]
  s_barrier
  ds_read_b128 v[180:183], v126 offset:0
  ds_read_b64_tr_b16 v[196:197], v128 offset:0
  ds_read_b64_tr_b16 v[198:199], v128 offset:768
  ds_read_b128 v[184:187], v126 offset:2048
  ds_read_b64_tr_b16 v[200:201], v130 offset:0
  ds_read_b64_tr_b16 v[202:203], v130 offset:768
  ds_read_b128 v[188:191], v126 offset:4096
  ds_read_b64_tr_b16 v[204:205], v132 offset:0
  ds_read_b64_tr_b16 v[206:207], v132 offset:768
  ds_read_b128 v[192:195], v126 offset:6144
  s_waitcnt lgkmcnt(7)
  v_mfma_f32_16x16x32_bf16 v[64:67], v[196:199], v[180:183], v[64:67]
  ds_read_b128 v[208:211], v127 offset:0
  s_waitcnt lgkmcnt(7)
  v_mfma_f32_16x16x32_bf16 v[76:79], v[196:199], v[184:187], v[76:79]
  ds_read_b64_tr_b16 v[224:225], v128 offset:6144
  s_waitcnt lgkmcnt(5)
  v_mfma_f32_16x16x32_bf16 v[88:91], v[196:199], v[188:191], v[88:91]
  ds_read_b64_tr_b16 v[226:227], v128 offset:6912
  s_waitcnt lgkmcnt(3)
  v_mfma_f32_16x16x32_bf16 v[100:103], v[196:199], v[192:195], v[100:103]
  ds_read_b128 v[212:215], v127 offset:2048
  v_mfma_f32_16x16x32_bf16 v[68:71], v[200:203], v[180:183], v[68:71]
  ds_read_b64_tr_b16 v[228:229], v130 offset:6144
  v_mfma_f32_16x16x32_bf16 v[80:83], v[200:203], v[184:187], v[80:83]
  ds_read_b64_tr_b16 v[230:231], v130 offset:6912
  v_mfma_f32_16x16x32_bf16 v[92:95], v[200:203], v[188:191], v[92:95]
  ds_read_b128 v[216:219], v127 offset:4096
  v_mfma_f32_16x16x32_bf16 v[104:107], v[200:203], v[192:195], v[104:107]
  ds_read_b64_tr_b16 v[232:233], v132 offset:6144
  v_mfma_f32_16x16x32_bf16 v[72:75], v[204:207], v[180:183], v[72:75]
  ds_read_b64_tr_b16 v[234:235], v132 offset:6912
  v_mfma_f32_16x16x32_bf16 v[84:87], v[204:207], v[184:187], v[84:87]
  ds_read_b128 v[220:223], v127 offset:6144
  v_mfma_f32_16x16x32_bf16 v[96:99], v[204:207], v[188:191], v[96:99]
  v_mfma_f32_16x16x32_bf16 v[108:111], v[204:207], v[192:195], v[108:111]
  s_waitcnt lgkmcnt(0)
  s_barrier
  v_mfma_f32_16x16x32_bf16 v[64:67], v[224:227], v[208:211], v[64:67]
  ds_read_b128 v[180:183], v126 offset:16384
  v_mfma_f32_16x16x32_bf16 v[76:79], v[224:227], v[212:215], v[76:79]
  ds_read_b64_tr_b16 v[196:197], v128 offset:12288
  v_mfma_f32_16x16x32_bf16 v[88:91], v[224:227], v[216:219], v[88:91]
  ds_read_b64_tr_b16 v[198:199], v128 offset:13056
  v_mfma_f32_16x16x32_bf16 v[100:103], v[224:227], v[220:223], v[100:103]
  ds_read_b128 v[184:187], v126 offset:18432
  v_mfma_f32_16x16x32_bf16 v[68:71], v[228:231], v[208:211], v[68:71]
  ds_read_b64_tr_b16 v[200:201], v130 offset:12288
  v_mfma_f32_16x16x32_bf16 v[80:83], v[228:231], v[212:215], v[80:83]
  ds_read_b64_tr_b16 v[202:203], v130 offset:13056
  v_mfma_f32_16x16x32_bf16 v[92:95], v[228:231], v[216:219], v[92:95]
  ds_read_b128 v[188:191], v126 offset:20480
  v_mfma_f32_16x16x32_bf16 v[104:107], v[228:231], v[220:223], v[104:107]
  ds_read_b64_tr_b16 v[204:205], v132 offset:12288
  v_mfma_f32_16x16x32_bf16 v[72:75], v[232:235], v[208:211], v[72:75]
  ds_read_b64_tr_b16 v[206:207], v132 offset:13056
  v_mfma_f32_16x16x32_bf16 v[84:87], v[232:235], v[212:215], v[84:87]
  ds_read_b128 v[192:195], v126 offset:22528
  v_mfma_f32_16x16x32_bf16 v[96:99], v[232:235], v[216:219], v[96:99]
  v_mfma_f32_16x16x32_bf16 v[108:111], v[232:235], v[220:223], v[108:111]
  s_waitcnt lgkmcnt(7)
  v_mfma_f32_16x16x32_bf16 v[64:67], v[196:199], v[180:183], v[64:67]
  ds_read_b128 v[208:211], v127 offset:16384
  s_waitcnt lgkmcnt(7)
  v_mfma_f32_16x16x32_bf16 v[76:79], v[196:199], v[184:187], v[76:79]
  ds_read_b64_tr_b16 v[224:225], v128 offset:18432
  s_waitcnt lgkmcnt(5)
  v_mfma_f32_16x16x32_bf16 v[88:91], v[196:199], v[188:191], v[88:91]
  ds_read_b64_tr_b16 v[226:227], v128 offset:19200
  s_waitcnt lgkmcnt(3)
  v_mfma_f32_16x16x32_bf16 v[100:103], v[196:199], v[192:195], v[100:103]
  ds_read_b128 v[212:215], v127 offset:18432
  v_mfma_f32_16x16x32_bf16 v[68:71], v[200:203], v[180:183], v[68:71]
  ds_read_b64_tr_b16 v[228:229], v130 offset:18432
  v_mfma_f32_16x16x32_bf16 v[80:83], v[200:203], v[184:187], v[80:83]
  ds_read_b64_tr_b16 v[230:231], v130 offset:19200
  v_mfma_f32_16x16x32_bf16 v[92:95], v[200:203], v[188:191], v[92:95]
  ds_read_b128 v[216:219], v127 offset:20480
  v_mfma_f32_16x16x32_bf16 v[104:107], v[200:203], v[192:195], v[104:107]
  ds_read_b64_tr_b16 v[232:233], v132 offset:18432
  v_mfma_f32_16x16x32_bf16 v[72:75], v[204:207], v[180:183], v[72:75]
  ds_read_b64_tr_b16 v[234:235], v132 offset:19200
  v_mfma_f32_16x16x32_bf16 v[84:87], v[204:207], v[184:187], v[84:87]
  ds_read_b128 v[220:223], v127 offset:22528
  v_mfma_f32_16x16x32_bf16 v[96:99], v[204:207], v[188:191], v[96:99]
  v_mfma_f32_16x16x32_bf16 v[108:111], v[204:207], v[192:195], v[108:111]
  s_waitcnt lgkmcnt(0)
  s_barrier
  v_mfma_f32_16x16x32_bf16 v[64:67], v[224:227], v[208:211], v[64:67]
  ds_read_b128 v[180:183], v126 offset:32768
  v_mfma_f32_16x16x32_bf16 v[76:79], v[224:227], v[212:215], v[76:79]
  ds_read_b64_tr_b16 v[196:197], v128 offset:24576
  v_mfma_f32_16x16x32_bf16 v[88:91], v[224:227], v[216:219], v[88:91]
  ds_read_b64_tr_b16 v[198:199], v128 offset:25344
  v_mfma_f32_16x16x32_bf16 v[100:103], v[224:227], v[220:223], v[100:103]
  ds_read_b128 v[184:187], v126 offset:34816
  v_mfma_f32_16x16x32_bf16 v[68:71], v[228:231], v[208:211], v[68:71]
  ds_read_b64_tr_b16 v[200:201], v130 offset:24576
  v_mfma_f32_16x16x32_bf16 v[80:83], v[228:231], v[212:215], v[80:83]
  ds_read_b64_tr_b16 v[202:203], v130 offset:25344
  v_mfma_f32_16x16x32_bf16 v[92:95], v[228:231], v[216:219], v[92:95]
  ds_read_b128 v[188:191], v126 offset:36864
  v_mfma_f32_16x16x32_bf16 v[104:107], v[228:231], v[220:223], v[104:107]
  ds_read_b64_tr_b16 v[204:205], v132 offset:24576
  v_mfma_f32_16x16x32_bf16 v[72:75], v[232:235], v[208:211], v[72:75]
  ds_read_b64_tr_b16 v[206:207], v132 offset:25344
  v_mfma_f32_16x16x32_bf16 v[84:87], v[232:235], v[212:215], v[84:87]
  ds_read_b128 v[192:195], v126 offset:38912
  v_mfma_f32_16x16x32_bf16 v[96:99], v[232:235], v[216:219], v[96:99]
  v_mfma_f32_16x16x32_bf16 v[108:111], v[232:235], v[220:223], v[108:111]
  s_waitcnt lgkmcnt(7)
  v_mfma_f32_16x16x32_bf16 v[64:67], v[196:199], v[180:183], v[64:67]
  ds_read_b128 v[208:211], v127 offset:32768
  s_waitcnt lgkmcnt(7)
  v_mfma_f32_16x16x32_bf16 v[76:79], v[196:199], v[184:187], v[76:79]
  ds_read_b64_tr_b16 v[224:225], v128 offset:30720
  s_waitcnt lgkmcnt(5)
  v_mfma_f32_16x16x32_bf16 v[88:91], v[196:199], v[188:191], v[88:91]
  ds_read_b64_tr_b16 v[226:227], v128 offset:31488
  s_waitcnt lgkmcnt(3)
  v_mfma_f32_16x16x32_bf16 v[100:103], v[196:199], v[192:195], v[100:103]
  ds_read_b128 v[212:215], v127 offset:34816
  v_mfma_f32_16x16x32_bf16 v[68:71], v[200:203], v[180:183], v[68:71]
  ds_read_b64_tr_b16 v[228:229], v130 offset:30720
  v_mfma_f32_16x16x32_bf16 v[80:83], v[200:203], v[184:187], v[80:83]
  ds_read_b64_tr_b16 v[230:231], v130 offset:31488
  v_mfma_f32_16x16x32_bf16 v[92:95], v[200:203], v[188:191], v[92:95]
  ds_read_b128 v[216:219], v127 offset:36864
  v_mfma_f32_16x16x32_bf16 v[104:107], v[200:203], v[192:195], v[104:107]
  ds_read_b64_tr_b16 v[232:233], v132 offset:30720
  v_mfma_f32_16x16x32_bf16 v[72:75], v[204:207], v[180:183], v[72:75]
  ds_read_b64_tr_b16 v[234:235], v132 offset:31488
  v_mfma_f32_16x16x32_bf16 v[84:87], v[204:207], v[184:187], v[84:87]
  ds_read_b128 v[220:223], v127 offset:38912
  v_mfma_f32_16x16x32_bf16 v[96:99], v[204:207], v[188:191], v[96:99]
  v_mfma_f32_16x16x32_bf16 v[108:111], v[204:207], v[192:195], v[108:111]
  s_waitcnt lgkmcnt(0)
  s_barrier
  v_mfma_f32_16x16x32_bf16 v[64:67], v[224:227], v[208:211], v[64:67]
  ds_read_b128 v[180:183], v126 offset:49152
  v_mfma_f32_16x16x32_bf16 v[76:79], v[224:227], v[212:215], v[76:79]
  ds_read_b64_tr_b16 v[196:197], v128 offset:36864
  v_mfma_f32_16x16x32_bf16 v[88:91], v[224:227], v[216:219], v[88:91]
  ds_read_b64_tr_b16 v[198:199], v128 offset:37632
  v_mfma_f32_16x16x32_bf16 v[100:103], v[224:227], v[220:223], v[100:103]
  ds_read_b128 v[184:187], v126 offset:51200
  v_mfma_f32_16x16x32_bf16 v[68:71], v[228:231], v[208:211], v[68:71]
  ds_read_b64_tr_b16 v[200:201], v130 offset:36864
  v_mfma_f32_16x16x32_bf16 v[80:83], v[228:231], v[212:215], v[80:83]
  ds_read_b64_tr_b16 v[202:203], v130 offset:37632
  v_mfma_f32_16x16x32_bf16 v[92:95], v[228:231], v[216:219], v[92:95]
  ds_read_b128 v[188:191], v126 offset:53248
  v_mfma_f32_16x16x32_bf16 v[104:107], v[228:231], v[220:223], v[104:107]
  ds_read_b64_tr_b16 v[204:205], v132 offset:36864
  v_mfma_f32_16x16x32_bf16 v[72:75], v[232:235], v[208:211], v[72:75]
  ds_read_b64_tr_b16 v[206:207], v132 offset:37632
  v_mfma_f32_16x16x32_bf16 v[84:87], v[232:235], v[212:215], v[84:87]
  ds_read_b128 v[192:195], v126 offset:55296
  v_mfma_f32_16x16x32_bf16 v[96:99], v[232:235], v[216:219], v[96:99]
  v_mfma_f32_16x16x32_bf16 v[108:111], v[232:235], v[220:223], v[108:111]
  s_waitcnt lgkmcnt(7)
  v_mfma_f32_16x16x32_bf16 v[64:67], v[196:199], v[180:183], v[64:67]
  ds_read_b128 v[208:211], v127 offset:49152
  s_waitcnt lgkmcnt(7)
  v_mfma_f32_16x16x32_bf16 v[76:79], v[196:199], v[184:187], v[76:79]
  ds_read_b64_tr_b16 v[224:225], v128 offset:43008
  s_waitcnt lgkmcnt(5)
  v_mfma_f32_16x16x32_bf16 v[88:91], v[196:199], v[188:191], v[88:91]
  ds_read_b64_tr_b16 v[226:227], v128 offset:43776
  s_waitcnt lgkmcnt(3)
  v_mfma_f32_16x16x32_bf16 v[100:103], v[196:199], v[192:195], v[100:103]
  ds_read_b128 v[212:215], v127 offset:51200
  v_mfma_f32_16x16x32_bf16 v[68:71], v[200:203], v[180:183], v[68:71]
  ds_read_b64_tr_b16 v[228:229], v130 offset:43008
  v_mfma_f32_16x16x32_bf16 v[80:83], v[200:203], v[184:187], v[80:83]
  ds_read_b64_tr_b16 v[230:231], v130 offset:43776
  v_mfma_f32_16x16x32_bf16 v[92:95], v[200:203], v[188:191], v[92:95]
  ds_read_b128 v[216:219], v127 offset:53248
  v_mfma_f32_16x16x32_bf16 v[104:107], v[200:203], v[192:195], v[104:107]
  ds_read_b64_tr_b16 v[232:233], v132 offset:43008
  v_mfma_f32_16x16x32_bf16 v[72:75], v[204:207], v[180:183], v[72:75]
  ds_read_b64_tr_b16 v[234:235], v132 offset:43776
  v_mfma_f32_16x16x32_bf16 v[84:87], v[204:207], v[184:187], v[84:87]
  ds_read_b128 v[220:223], v127 offset:55296
  v_mfma_f32_16x16x32_bf16 v[96:99], v[204:207], v[188:191], v[96:99]
  v_mfma_f32_16x16x32_bf16 v[108:111], v[204:207], v[192:195], v[108:111]
  s_waitcnt lgkmcnt(0)
  s_barrier
  v_mfma_f32_16x16x32_bf16 v[64:67], v[224:227], v[208:211], v[64:67]
  ds_read_b128 v[180:183], v126 offset:0
  v_mfma_f32_16x16x32_bf16 v[76:79], v[224:227], v[212:215], v[76:79]
  ds_read_b64_tr_b16 v[196:197], v129 offset:0
  v_mfma_f32_16x16x32_bf16 v[88:91], v[224:227], v[216:219], v[88:91]
  ds_read_b64_tr_b16 v[198:199], v129 offset:768
  v_mfma_f32_16x16x32_bf16 v[100:103], v[224:227], v[220:223], v[100:103]
  ds_read_b128 v[184:187], v126 offset:2048
  v_mfma_f32_16x16x32_bf16 v[68:71], v[228:231], v[208:211], v[68:71]
  ds_read_b64_tr_b16 v[200:201], v131 offset:0
  v_mfma_f32_16x16x32_bf16 v[80:83], v[228:231], v[212:215], v[80:83]
  ds_read_b64_tr_b16 v[202:203], v131 offset:768
  v_mfma_f32_16x16x32_bf16 v[92:95], v[228:231], v[216:219], v[92:95]
  ds_read_b128 v[188:191], v126 offset:4096
  v_mfma_f32_16x16x32_bf16 v[104:107], v[228:231], v[220:223], v[104:107]
  ds_read_b64_tr_b16 v[204:205], v133 offset:0
  v_mfma_f32_16x16x32_bf16 v[72:75], v[232:235], v[208:211], v[72:75]
  ds_read_b64_tr_b16 v[206:207], v133 offset:768
  v_mfma_f32_16x16x32_bf16 v[84:87], v[232:235], v[212:215], v[84:87]
  ds_read_b128 v[192:195], v126 offset:6144
  v_mfma_f32_16x16x32_bf16 v[96:99], v[232:235], v[216:219], v[96:99]
  v_mfma_f32_16x16x32_bf16 v[108:111], v[232:235], v[220:223], v[108:111]
  s_waitcnt lgkmcnt(7)
  v_mfma_f32_16x16x32_bf16 v[64:67], v[196:199], v[180:183], v[64:67]
  ds_read_b128 v[208:211], v127 offset:0
  s_waitcnt lgkmcnt(7)
  v_mfma_f32_16x16x32_bf16 v[76:79], v[196:199], v[184:187], v[76:79]
  ds_read_b64_tr_b16 v[224:225], v129 offset:6144
  s_waitcnt lgkmcnt(5)
  v_mfma_f32_16x16x32_bf16 v[88:91], v[196:199], v[188:191], v[88:91]
  ds_read_b64_tr_b16 v[226:227], v129 offset:6912
  s_waitcnt lgkmcnt(3)
  v_mfma_f32_16x16x32_bf16 v[100:103], v[196:199], v[192:195], v[100:103]
  ds_read_b128 v[212:215], v127 offset:2048
  v_mfma_f32_16x16x32_bf16 v[68:71], v[200:203], v[180:183], v[68:71]
  ds_read_b64_tr_b16 v[228:229], v131 offset:6144
  v_mfma_f32_16x16x32_bf16 v[80:83], v[200:203], v[184:187], v[80:83]
  ds_read_b64_tr_b16 v[230:231], v131 offset:6912
  v_mfma_f32_16x16x32_bf16 v[92:95], v[200:203], v[188:191], v[92:95]
  ds_read_b128 v[216:219], v127 offset:4096
  v_mfma_f32_16x16x32_bf16 v[104:107], v[200:203], v[192:195], v[104:107]
  ds_read_b64_tr_b16 v[232:233], v133 offset:6144
  v_mfma_f32_16x16x32_bf16 v[72:75], v[204:207], v[180:183], v[72:75]
  ds_read_b64_tr_b16 v[234:235], v133 offset:6912
  v_mfma_f32_16x16x32_bf16 v[84:87], v[204:207], v[184:187], v[84:87]
  ds_read_b128 v[220:223], v127 offset:6144
  v_mfma_f32_16x16x32_bf16 v[96:99], v[204:207], v[188:191], v[96:99]
  v_mfma_f32_16x16x32_bf16 v[108:111], v[204:207], v[192:195], v[108:111]
  s_waitcnt lgkmcnt(0)
  s_barrier
  v_mfma_f32_16x16x32_bf16 v[64:67], v[224:227], v[208:211], v[64:67]
  ds_read_b128 v[180:183], v126 offset:16384
  v_mfma_f32_16x16x32_bf16 v[76:79], v[224:227], v[212:215], v[76:79]
  ds_read_b64_tr_b16 v[196:197], v129 offset:12288
  v_mfma_f32_16x16x32_bf16 v[88:91], v[224:227], v[216:219], v[88:91]
  ds_read_b64_tr_b16 v[198:199], v129 offset:13056
  v_mfma_f32_16x16x32_bf16 v[100:103], v[224:227], v[220:223], v[100:103]
  ds_read_b128 v[184:187], v126 offset:18432
  v_mfma_f32_16x16x32_bf16 v[68:71], v[228:231], v[208:211], v[68:71]
  ds_read_b64_tr_b16 v[200:201], v131 offset:12288
  v_mfma_f32_16x16x32_bf16 v[80:83], v[228:231], v[212:215], v[80:83]
  ds_read_b64_tr_b16 v[202:203], v131 offset:13056
  v_mfma_f32_16x16x32_bf16 v[92:95], v[228:231], v[216:219], v[92:95]
  ds_read_b128 v[188:191], v126 offset:20480
  v_mfma_f32_16x16x32_bf16 v[104:107], v[228:231], v[220:223], v[104:107]
  ds_read_b64_tr_b16 v[204:205], v133 offset:12288
  v_mfma_f32_16x16x32_bf16 v[72:75], v[232:235], v[208:211], v[72:75]
  ds_read_b64_tr_b16 v[206:207], v133 offset:13056
  v_mfma_f32_16x16x32_bf16 v[84:87], v[232:235], v[212:215], v[84:87]
  ds_read_b128 v[192:195], v126 offset:22528
  v_mfma_f32_16x16x32_bf16 v[96:99], v[232:235], v[216:219], v[96:99]
  v_mfma_f32_16x16x32_bf16 v[108:111], v[232:235], v[220:223], v[108:111]
  s_waitcnt lgkmcnt(7)
  v_mfma_f32_16x16x32_bf16 v[64:67], v[196:199], v[180:183], v[64:67]
  ds_read_b128 v[208:211], v127 offset:16384
  s_waitcnt lgkmcnt(7)
  v_mfma_f32_16x16x32_bf16 v[76:79], v[196:199], v[184:187], v[76:79]
  ds_read_b64_tr_b16 v[224:225], v129 offset:18432
  s_waitcnt lgkmcnt(5)
  v_mfma_f32_16x16x32_bf16 v[88:91], v[196:199], v[188:191], v[88:91]
  ds_read_b64_tr_b16 v[226:227], v129 offset:19200
  s_waitcnt lgkmcnt(3)
  v_mfma_f32_16x16x32_bf16 v[100:103], v[196:199], v[192:195], v[100:103]
  ds_read_b128 v[212:215], v127 offset:18432
  v_mfma_f32_16x16x32_bf16 v[68:71], v[200:203], v[180:183], v[68:71]
  ds_read_b64_tr_b16 v[228:229], v131 offset:18432
  v_mfma_f32_16x16x32_bf16 v[80:83], v[200:203], v[184:187], v[80:83]
  ds_read_b64_tr_b16 v[230:231], v131 offset:19200
  v_mfma_f32_16x16x32_bf16 v[92:95], v[200:203], v[188:191], v[92:95]
  ds_read_b128 v[216:219], v127 offset:20480
  v_mfma_f32_16x16x32_bf16 v[104:107], v[200:203], v[192:195], v[104:107]
  ds_read_b64_tr_b16 v[232:233], v133 offset:18432
  v_mfma_f32_16x16x32_bf16 v[72:75], v[204:207], v[180:183], v[72:75]
  ds_read_b64_tr_b16 v[234:235], v133 offset:19200
  v_mfma_f32_16x16x32_bf16 v[84:87], v[204:207], v[184:187], v[84:87]
  ds_read_b128 v[220:223], v127 offset:22528
  v_mfma_f32_16x16x32_bf16 v[96:99], v[204:207], v[188:191], v[96:99]
  v_mfma_f32_16x16x32_bf16 v[108:111], v[204:207], v[192:195], v[108:111]
  s_waitcnt lgkmcnt(0)
  s_barrier
  ds_read_b32 v148, v134 offset:0
  ds_read_b32 v150, v134 offset:512
  ds_read_b32 v152, v134 offset:1024
  ds_read_b32 v154, v134 offset:1536
  ds_read_b32 v156, v134 offset:64
  ds_read_b32 v158, v134 offset:576
  ds_read_b32 v160, v134 offset:1088
  ds_read_b32 v162, v134 offset:1600
  ds_read_b32 v164, v134 offset:128
  ds_read_b32 v166, v134 offset:640
  ds_read_b32 v168, v134 offset:1152
  ds_read_b32 v170, v134 offset:1664
  ds_read_b32 v172, v134 offset:192
  ds_read_b32 v174, v134 offset:704
  ds_read_b32 v176, v134 offset:1216
  ds_read_b32 v178, v134 offset:1728
  v_mfma_f32_16x16x32_bf16 v[64:67], v[224:227], v[208:211], v[64:67]
  ds_read_b128 v[180:183], v126 offset:32768
  v_mfma_f32_16x16x32_bf16 v[76:79], v[224:227], v[212:215], v[76:79]
  ds_read_b64_tr_b16 v[196:197], v129 offset:24576
  v_mfma_f32_16x16x32_bf16 v[88:91], v[224:227], v[216:219], v[88:91]
  ds_read_b64_tr_b16 v[198:199], v129 offset:25344
  v_mfma_f32_16x16x32_bf16 v[100:103], v[224:227], v[220:223], v[100:103]
  ds_read_b128 v[184:187], v126 offset:34816
  v_mfma_f32_16x16x32_bf16 v[68:71], v[228:231], v[208:211], v[68:71]
  ds_read_b64_tr_b16 v[200:201], v131 offset:24576
  v_mfma_f32_16x16x32_bf16 v[80:83], v[228:231], v[212:215], v[80:83]
  ds_read_b64_tr_b16 v[202:203], v131 offset:25344
  v_mfma_f32_16x16x32_bf16 v[92:95], v[228:231], v[216:219], v[92:95]
  ds_read_b128 v[188:191], v126 offset:36864
  v_mfma_f32_16x16x32_bf16 v[104:107], v[228:231], v[220:223], v[104:107]
  ds_read_b64_tr_b16 v[204:205], v133 offset:24576
  v_mfma_f32_16x16x32_bf16 v[72:75], v[232:235], v[208:211], v[72:75]
  ds_read_b64_tr_b16 v[206:207], v133 offset:25344
  v_mfma_f32_16x16x32_bf16 v[84:87], v[232:235], v[212:215], v[84:87]
  ds_read_b128 v[192:195], v126 offset:38912
  v_mfma_f32_16x16x32_bf16 v[96:99], v[232:235], v[216:219], v[96:99]
  v_mfma_f32_16x16x32_bf16 v[108:111], v[232:235], v[220:223], v[108:111]
  s_waitcnt lgkmcnt(7)
  v_mfma_f32_16x16x32_bf16 v[64:67], v[196:199], v[180:183], v[64:67]
  ds_read_b128 v[208:211], v127 offset:32768
  s_waitcnt lgkmcnt(7)
  v_mfma_f32_16x16x32_bf16 v[76:79], v[196:199], v[184:187], v[76:79]
  ds_read_b64_tr_b16 v[224:225], v129 offset:30720
  s_waitcnt lgkmcnt(5)
  v_mfma_f32_16x16x32_bf16 v[88:91], v[196:199], v[188:191], v[88:91]
  ds_read_b64_tr_b16 v[226:227], v129 offset:31488
  s_waitcnt lgkmcnt(3)
  v_mfma_f32_16x16x32_bf16 v[100:103], v[196:199], v[192:195], v[100:103]
  ds_read_b128 v[212:215], v127 offset:34816
  v_mfma_f32_16x16x32_bf16 v[68:71], v[200:203], v[180:183], v[68:71]
  ds_read_b64_tr_b16 v[228:229], v131 offset:30720
  v_mfma_f32_16x16x32_bf16 v[80:83], v[200:203], v[184:187], v[80:83]
  ds_read_b64_tr_b16 v[230:231], v131 offset:31488
  v_mfma_f32_16x16x32_bf16 v[92:95], v[200:203], v[188:191], v[92:95]
  ds_read_b128 v[216:219], v127 offset:36864
  v_mfma_f32_16x16x32_bf16 v[104:107], v[200:203], v[192:195], v[104:107]
  ds_read_b64_tr_b16 v[232:233], v133 offset:30720
  v_mfma_f32_16x16x32_bf16 v[72:75], v[204:207], v[180:183], v[72:75]
  ds_read_b64_tr_b16 v[234:235], v133 offset:31488
  v_mfma_f32_16x16x32_bf16 v[84:87], v[204:207], v[184:187], v[84:87]
  ds_read_b128 v[220:223], v127 offset:38912
  v_mfma_f32_16x16x32_bf16 v[96:99], v[204:207], v[188:191], v[96:99]
  v_mfma_f32_16x16x32_bf16 v[108:111], v[204:207], v[192:195], v[108:111]
  s_waitcnt lgkmcnt(0)
  s_barrier
  v_mfma_f32_16x16x32_bf16 v[64:67], v[224:227], v[208:211], v[64:67]
  ds_read_b128 v[180:183], v126 offset:49152
  v_mfma_f32_16x16x32_bf16 v[76:79], v[224:227], v[212:215], v[76:79]
  ds_read_b64_tr_b16 v[196:197], v129 offset:36864
  v_mfma_f32_16x16x32_bf16 v[88:91], v[224:227], v[216:219], v[88:91]
  ds_read_b64_tr_b16 v[198:199], v129 offset:37632
  v_mfma_f32_16x16x32_bf16 v[100:103], v[224:227], v[220:223], v[100:103]
  ds_read_b128 v[184:187], v126 offset:51200
  v_mfma_f32_16x16x32_bf16 v[68:71], v[228:231], v[208:211], v[68:71]
  ds_read_b64_tr_b16 v[200:201], v131 offset:36864
  v_mfma_f32_16x16x32_bf16 v[80:83], v[228:231], v[212:215], v[80:83]
  ds_read_b64_tr_b16 v[202:203], v131 offset:37632
  v_mfma_f32_16x16x32_bf16 v[92:95], v[228:231], v[216:219], v[92:95]
  ds_read_b128 v[188:191], v126 offset:53248
  v_mfma_f32_16x16x32_bf16 v[104:107], v[228:231], v[220:223], v[104:107]
  ds_read_b64_tr_b16 v[204:205], v133 offset:36864
  v_mfma_f32_16x16x32_bf16 v[72:75], v[232:235], v[208:211], v[72:75]
  ds_read_b64_tr_b16 v[206:207], v133 offset:37632
  v_mfma_f32_16x16x32_bf16 v[84:87], v[232:235], v[212:215], v[84:87]
  ds_read_b128 v[192:195], v126 offset:55296
  v_mfma_f32_16x16x32_bf16 v[96:99], v[232:235], v[216:219], v[96:99]
  v_mfma_f32_16x16x32_bf16 v[108:111], v[232:235], v[220:223], v[108:111]
  s_waitcnt lgkmcnt(7)
  v_mfma_f32_16x16x32_bf16 v[64:67], v[196:199], v[180:183], v[64:67]
  ds_read_b128 v[208:211], v127 offset:49152
  s_waitcnt lgkmcnt(7)
  v_mfma_f32_16x16x32_bf16 v[76:79], v[196:199], v[184:187], v[76:79]
  ds_read_b64_tr_b16 v[224:225], v129 offset:43008
  s_waitcnt lgkmcnt(5)
  v_mfma_f32_16x16x32_bf16 v[88:91], v[196:199], v[188:191], v[88:91]
  ds_read_b64_tr_b16 v[226:227], v129 offset:43776
  s_waitcnt lgkmcnt(3)
  v_mfma_f32_16x16x32_bf16 v[100:103], v[196:199], v[192:195], v[100:103]
  ds_read_b128 v[212:215], v127 offset:51200
  v_mfma_f32_16x16x32_bf16 v[68:71], v[200:203], v[180:183], v[68:71]
  ds_read_b64_tr_b16 v[228:229], v131 offset:43008
  v_mfma_f32_16x16x32_bf16 v[80:83], v[200:203], v[184:187], v[80:83]
  ds_read_b64_tr_b16 v[230:231], v131 offset:43776
  v_mfma_f32_16x16x32_bf16 v[92:95], v[200:203], v[188:191], v[92:95]
  ds_read_b128 v[216:219], v127 offset:53248
  v_mfma_f32_16x16x32_bf16 v[104:107], v[200:203], v[192:195], v[104:107]
  ds_read_b64_tr_b16 v[232:233], v133 offset:43008
  v_mfma_f32_16x16x32_bf16 v[72:75], v[204:207], v[180:183], v[72:75]
  ds_read_b64_tr_b16 v[234:235], v133 offset:43776
  v_mfma_f32_16x16x32_bf16 v[84:87], v[204:207], v[184:187], v[84:87]
  ds_read_b128 v[220:223], v127 offset:55296
  v_mfma_f32_16x16x32_bf16 v[96:99], v[204:207], v[188:191], v[96:99]
  v_mfma_f32_16x16x32_bf16 v[108:111], v[204:207], v[192:195], v[108:111]
  s_waitcnt lgkmcnt(7)
  v_mfma_f32_16x16x32_bf16 v[64:67], v[224:227], v[208:211], v[64:67]
  s_waitcnt lgkmcnt(6)
  v_mfma_f32_16x16x32_bf16 v[76:79], v[224:227], v[212:215], v[76:79]
  s_waitcnt lgkmcnt(3)
  v_mfma_f32_16x16x32_bf16 v[88:91], v[224:227], v[216:219], v[88:91]
  s_waitcnt lgkmcnt(0)
  v_mfma_f32_16x16x32_bf16 v[100:103], v[224:227], v[220:223], v[100:103]
  v_mfma_f32_16x16x32_bf16 v[68:71], v[228:231], v[208:211], v[68:71]
  v_mfma_f32_16x16x32_bf16 v[80:83], v[228:231], v[212:215], v[80:83]
  v_mfma_f32_16x16x32_bf16 v[92:95], v[228:231], v[216:219], v[92:95]
  v_mfma_f32_16x16x32_bf16 v[104:107], v[228:231], v[220:223], v[104:107]
  v_mfma_f32_16x16x32_bf16 v[72:75], v[232:235], v[208:211], v[72:75]
  v_mfma_f32_16x16x32_bf16 v[84:87], v[232:235], v[212:215], v[84:87]
  v_mfma_f32_16x16x32_bf16 v[96:99], v[232:235], v[216:219], v[96:99]
  v_mfma_f32_16x16x32_bf16 v[108:111], v[232:235], v[220:223], v[108:111]
  s_barrier
  v_pk_fma_f32 v[64:65], v[112:113], v[148:149], v[64:65] op_sel_hi:[1,0,1] neg_lo:[0,1,0] neg_hi:[0,1,0]
  v_pk_fma_f32 v[66:67], v[114:115], v[148:149], v[66:67] op_sel_hi:[1,0,1] neg_lo:[0,1,0] neg_hi:[0,1,0]
  v_pk_fma_f32 v[68:69], v[116:117], v[148:149], v[68:69] op_sel_hi:[1,0,1] neg_lo:[0,1,0] neg_hi:[0,1,0]
  v_pk_fma_f32 v[70:71], v[118:119], v[148:149], v[70:71] op_sel_hi:[1,0,1] neg_lo:[0,1,0] neg_hi:[0,1,0]
  v_pk_fma_f32 v[72:73], v[120:121], v[148:149], v[72:73] op_sel_hi:[1,0,1] neg_lo:[0,1,0] neg_hi:[0,1,0]
  v_pk_fma_f32 v[74:75], v[122:123], v[148:149], v[74:75] op_sel_hi:[1,0,1] neg_lo:[0,1,0] neg_hi:[0,1,0]
  v_pk_mul_f32 v[180:181], v[64:65], v[64:65]
  v_pk_mul_f32 v[182:183], v[66:67], v[66:67]
  v_pk_mul_f32 v[184:185], v[68:69], v[68:69]
  v_pk_mul_f32 v[186:187], v[70:71], v[70:71]
  v_pk_mul_f32 v[188:189], v[72:73], v[72:73]
  v_pk_mul_f32 v[190:191], v[74:75], v[74:75]
  v_pk_fma_f32 v[180:181], v[180:181], v[152:153], v[150:151] op_sel_hi:[1,0,0]
  v_pk_fma_f32 v[182:183], v[182:183], v[152:153], v[150:151] op_sel_hi:[1,0,0]
  v_pk_fma_f32 v[184:185], v[184:185], v[152:153], v[150:151] op_sel_hi:[1,0,0]
  v_pk_fma_f32 v[186:187], v[186:187], v[152:153], v[150:151] op_sel_hi:[1,0,0]
  v_pk_fma_f32 v[188:189], v[188:189], v[152:153], v[150:151] op_sel_hi:[1,0,0]
  v_pk_fma_f32 v[190:191], v[190:191], v[152:153], v[150:151] op_sel_hi:[1,0,0]
  v_pk_mul_f32 v[180:181], v[180:181], v[64:65]
  v_pk_mul_f32 v[182:183], v[182:183], v[66:67]
  v_pk_mul_f32 v[184:185], v[184:185], v[68:69]
  v_pk_mul_f32 v[186:187], v[186:187], v[70:71]
  v_pk_mul_f32 v[188:189], v[188:189], v[72:73]
  v_pk_mul_f32 v[190:191], v[190:191], v[74:75]
  v_exp_f32 v180, v180
  v_exp_f32 v181, v181
  v_exp_f32 v182, v182
  v_exp_f32 v183, v183
  v_exp_f32 v184, v184
  v_exp_f32 v185, v185
  v_exp_f32 v186, v186
  v_exp_f32 v187, v187
  v_exp_f32 v188, v188
  v_exp_f32 v189, v189
  v_exp_f32 v190, v190
  v_exp_f32 v191, v191
  v_pk_fma_f32 v[180:181], v[180:181], v[154:155], v[154:155] op_sel_hi:[1,0,0]
  v_pk_fma_f32 v[182:183], v[182:183], v[154:155], v[154:155] op_sel_hi:[1,0,0]
  v_pk_fma_f32 v[184:185], v[184:185], v[154:155], v[154:155] op_sel_hi:[1,0,0]
  v_pk_fma_f32 v[186:187], v[186:187], v[154:155], v[154:155] op_sel_hi:[1,0,0]
  v_pk_fma_f32 v[188:189], v[188:189], v[154:155], v[154:155] op_sel_hi:[1,0,0]
  v_pk_fma_f32 v[190:191], v[190:191], v[154:155], v[154:155] op_sel_hi:[1,0,0]
  v_rcp_f32 v180, v180
  v_rcp_f32 v181, v181
  v_rcp_f32 v182, v182
  v_rcp_f32 v183, v183
  v_rcp_f32 v184, v184
  v_rcp_f32 v185, v185
  v_rcp_f32 v186, v186
  v_rcp_f32 v187, v187
  v_rcp_f32 v188, v188
  v_rcp_f32 v189, v189
  v_rcp_f32 v190, v190
  v_rcp_f32 v191, v191
  v_pk_mul_f32 v[64:65], v[64:65], v[180:181]
  v_pk_mul_f32 v[66:67], v[66:67], v[182:183]
  v_pk_mul_f32 v[68:69], v[68:69], v[184:185]
  v_pk_mul_f32 v[70:71], v[70:71], v[186:187]
  v_pk_mul_f32 v[72:73], v[72:73], v[188:189]
  v_pk_mul_f32 v[74:75], v[74:75], v[190:191]
  v_cvt_pk_bf16_f32 v192, v64, v65
  v_cvt_pk_bf16_f32 v193, v66, v67
  ds_write_b64 v135, v[192:193] offset:0
  v_cvt_pk_bf16_f32 v194, v68, v69
  v_cvt_pk_bf16_f32 v195, v70, v71
  ds_write_b64 v135, v[194:195] offset:32
  v_cvt_pk_bf16_f32 v196, v72, v73
  v_cvt_pk_bf16_f32 v197, v74, v75
  ds_write_b64 v135, v[196:197] offset:64
  v_pk_fma_f32 v[76:77], v[112:113], v[156:157], v[76:77] op_sel_hi:[1,0,1] neg_lo:[0,1,0] neg_hi:[0,1,0]
  v_pk_fma_f32 v[78:79], v[114:115], v[156:157], v[78:79] op_sel_hi:[1,0,1] neg_lo:[0,1,0] neg_hi:[0,1,0]
  v_pk_fma_f32 v[80:81], v[116:117], v[156:157], v[80:81] op_sel_hi:[1,0,1] neg_lo:[0,1,0] neg_hi:[0,1,0]
  v_pk_fma_f32 v[82:83], v[118:119], v[156:157], v[82:83] op_sel_hi:[1,0,1] neg_lo:[0,1,0] neg_hi:[0,1,0]
  v_pk_fma_f32 v[84:85], v[120:121], v[156:157], v[84:85] op_sel_hi:[1,0,1] neg_lo:[0,1,0] neg_hi:[0,1,0]
  v_pk_fma_f32 v[86:87], v[122:123], v[156:157], v[86:87] op_sel_hi:[1,0,1] neg_lo:[0,1,0] neg_hi:[0,1,0]
  v_pk_mul_f32 v[180:181], v[76:77], v[76:77]
  v_pk_mul_f32 v[182:183], v[78:79], v[78:79]
  v_pk_mul_f32 v[184:185], v[80:81], v[80:81]
  v_pk_mul_f32 v[186:187], v[82:83], v[82:83]
  v_pk_mul_f32 v[188:189], v[84:85], v[84:85]
  v_pk_mul_f32 v[190:191], v[86:87], v[86:87]
  v_pk_fma_f32 v[180:181], v[180:181], v[160:161], v[158:159] op_sel_hi:[1,0,0]
  v_pk_fma_f32 v[182:183], v[182:183], v[160:161], v[158:159] op_sel_hi:[1,0,0]
  v_pk_fma_f32 v[184:185], v[184:185], v[160:161], v[158:159] op_sel_hi:[1,0,0]
  v_pk_fma_f32 v[186:187], v[186:187], v[160:161], v[158:159] op_sel_hi:[1,0,0]
  v_pk_fma_f32 v[188:189], v[188:189], v[160:161], v[158:159] op_sel_hi:[1,0,0]
  v_pk_fma_f32 v[190:191], v[190:191], v[160:161], v[158:159] op_sel_hi:[1,0,0]
  v_pk_mul_f32 v[180:181], v[180:181], v[76:77]
  v_pk_mul_f32 v[182:183], v[182:183], v[78:79]
  v_pk_mul_f32 v[184:185], v[184:185], v[80:81]
  v_pk_mul_f32 v[186:187], v[186:187], v[82:83]
  v_pk_mul_f32 v[188:189], v[188:189], v[84:85]
  v_pk_mul_f32 v[190:191], v[190:191], v[86:87]
  v_exp_f32 v180, v180
  v_exp_f32 v181, v181
  v_exp_f32 v182, v182
  v_exp_f32 v183, v183
  v_exp_f32 v184, v184
  v_exp_f32 v185, v185
  v_exp_f32 v186, v186
  v_exp_f32 v187, v187
  v_exp_f32 v188, v188
  v_exp_f32 v189, v189
  v_exp_f32 v190, v190
  v_exp_f32 v191, v191
  v_pk_fma_f32 v[180:181], v[180:181], v[162:163], v[162:163] op_sel_hi:[1,0,0]
  v_pk_fma_f32 v[182:183], v[182:183], v[162:163], v[162:163] op_sel_hi:[1,0,0]
  v_pk_fma_f32 v[184:185], v[184:185], v[162:163], v[162:163] op_sel_hi:[1,0,0]
  v_pk_fma_f32 v[186:187], v[186:187], v[162:163], v[162:163] op_sel_hi:[1,0,0]
  v_pk_fma_f32 v[188:189], v[188:189], v[162:163], v[162:163] op_sel_hi:[1,0,0]
  v_pk_fma_f32 v[190:191], v[190:191], v[162:163], v[162:163] op_sel_hi:[1,0,0]
  v_rcp_f32 v180, v180
  v_rcp_f32 v181, v181
  v_rcp_f32 v182, v182
  v_rcp_f32 v183, v183
  v_rcp_f32 v184, v184
  v_rcp_f32 v185, v185
  v_rcp_f32 v186, v186
  v_rcp_f32 v187, v187
  v_rcp_f32 v188, v188
  v_rcp_f32 v189, v189
  v_rcp_f32 v190, v190
  v_rcp_f32 v191, v191
  v_pk_mul_f32 v[76:77], v[76:77], v[180:181]
  v_pk_mul_f32 v[78:79], v[78:79], v[182:183]
  v_pk_mul_f32 v[80:81], v[80:81], v[184:185]
  v_pk_mul_f32 v[82:83], v[82:83], v[186:187]
  v_pk_mul_f32 v[84:85], v[84:85], v[188:189]
  v_pk_mul_f32 v[86:87], v[86:87], v[190:191]
  v_cvt_pk_bf16_f32 v192, v76, v77
  v_cvt_pk_bf16_f32 v193, v78, v79
  ds_write_b64 v135, v[192:193] offset:3328
  v_cvt_pk_bf16_f32 v194, v80, v81
  v_cvt_pk_bf16_f32 v195, v82, v83
  ds_write_b64 v135, v[194:195] offset:3360
  v_cvt_pk_bf16_f32 v196, v84, v85
  v_cvt_pk_bf16_f32 v197, v86, v87
  ds_write_b64 v135, v[196:197] offset:3392
  s_waitcnt lgkmcnt(0)
  s_barrier
  v_pk_fma_f32 v[88:89], v[112:113], v[164:165], v[88:89] op_sel_hi:[1,0,1] neg_lo:[0,1,0] neg_hi:[0,1,0]
  v_pk_fma_f32 v[90:91], v[114:115], v[164:165], v[90:91] op_sel_hi:[1,0,1] neg_lo:[0,1,0] neg_hi:[0,1,0]
  v_pk_fma_f32 v[92:93], v[116:117], v[164:165], v[92:93] op_sel_hi:[1,0,1] neg_lo:[0,1,0] neg_hi:[0,1,0]
  v_pk_fma_f32 v[94:95], v[118:119], v[164:165], v[94:95] op_sel_hi:[1,0,1] neg_lo:[0,1,0] neg_hi:[0,1,0]
  v_pk_fma_f32 v[96:97], v[120:121], v[164:165], v[96:97] op_sel_hi:[1,0,1] neg_lo:[0,1,0] neg_hi:[0,1,0]
  v_pk_fma_f32 v[98:99], v[122:123], v[164:165], v[98:99] op_sel_hi:[1,0,1] neg_lo:[0,1,0] neg_hi:[0,1,0]
  v_pk_mul_f32 v[180:181], v[88:89], v[88:89]
  v_pk_mul_f32 v[182:183], v[90:91], v[90:91]
  v_pk_mul_f32 v[184:185], v[92:93], v[92:93]
  v_pk_mul_f32 v[186:187], v[94:95], v[94:95]
  v_pk_mul_f32 v[188:189], v[96:97], v[96:97]
  v_pk_mul_f32 v[190:191], v[98:99], v[98:99]
  v_pk_fma_f32 v[180:181], v[180:181], v[168:169], v[166:167] op_sel_hi:[1,0,0]
  v_pk_fma_f32 v[182:183], v[182:183], v[168:169], v[166:167] op_sel_hi:[1,0,0]
  v_pk_fma_f32 v[184:185], v[184:185], v[168:169], v[166:167] op_sel_hi:[1,0,0]
  v_pk_fma_f32 v[186:187], v[186:187], v[168:169], v[166:167] op_sel_hi:[1,0,0]
  v_pk_fma_f32 v[188:189], v[188:189], v[168:169], v[166:167] op_sel_hi:[1,0,0]
  v_pk_fma_f32 v[190:191], v[190:191], v[168:169], v[166:167] op_sel_hi:[1,0,0]
  v_pk_mul_f32 v[180:181], v[180:181], v[88:89]
  v_pk_mul_f32 v[182:183], v[182:183], v[90:91]
  v_pk_mul_f32 v[184:185], v[184:185], v[92:93]
  v_pk_mul_f32 v[186:187], v[186:187], v[94:95]
  v_pk_mul_f32 v[188:189], v[188:189], v[96:97]
  v_pk_mul_f32 v[190:191], v[190:191], v[98:99]
  v_exp_f32 v180, v180
  v_exp_f32 v181, v181
  v_exp_f32 v182, v182
  v_exp_f32 v183, v183
  v_exp_f32 v184, v184
  v_exp_f32 v185, v185
  v_exp_f32 v186, v186
  v_exp_f32 v187, v187
  v_exp_f32 v188, v188
  v_exp_f32 v189, v189
  v_exp_f32 v190, v190
  v_exp_f32 v191, v191
  v_pk_fma_f32 v[180:181], v[180:181], v[170:171], v[170:171] op_sel_hi:[1,0,0]
  v_pk_fma_f32 v[182:183], v[182:183], v[170:171], v[170:171] op_sel_hi:[1,0,0]
  v_pk_fma_f32 v[184:185], v[184:185], v[170:171], v[170:171] op_sel_hi:[1,0,0]
  v_pk_fma_f32 v[186:187], v[186:187], v[170:171], v[170:171] op_sel_hi:[1,0,0]
  v_pk_fma_f32 v[188:189], v[188:189], v[170:171], v[170:171] op_sel_hi:[1,0,0]
  v_pk_fma_f32 v[190:191], v[190:191], v[170:171], v[170:171] op_sel_hi:[1,0,0]
  v_rcp_f32 v180, v180
  v_rcp_f32 v181, v181
  v_rcp_f32 v182, v182
  v_rcp_f32 v183, v183
  v_rcp_f32 v184, v184
  v_rcp_f32 v185, v185
  v_rcp_f32 v186, v186
  v_rcp_f32 v187, v187
  v_rcp_f32 v188, v188
  v_rcp_f32 v189, v189
  v_rcp_f32 v190, v190
  v_rcp_f32 v191, v191
  v_pk_mul_f32 v[88:89], v[88:89], v[180:181]
  v_pk_mul_f32 v[90:91], v[90:91], v[182:183]
  v_pk_mul_f32 v[92:93], v[92:93], v[184:185]
  v_pk_mul_f32 v[94:95], v[94:95], v[186:187]
  v_pk_mul_f32 v[96:97], v[96:97], v[188:189]
  v_pk_mul_f32 v[98:99], v[98:99], v[190:191]
  v_cvt_pk_bf16_f32 v192, v88, v89
  v_cvt_pk_bf16_f32 v193, v90, v91
  ds_write_b64 v135, v[192:193] offset:6656
  v_cvt_pk_bf16_f32 v194, v92, v93
  v_cvt_pk_bf16_f32 v195, v94, v95
  ds_write_b64 v135, v[194:195] offset:6688
  v_cvt_pk_bf16_f32 v196, v96, v97
  v_cvt_pk_bf16_f32 v197, v98, v99
  ds_write_b64 v135, v[196:197] offset:6720
  v_pk_fma_f32 v[100:101], v[112:113], v[172:173], v[100:101] op_sel_hi:[1,0,1] neg_lo:[0,1,0] neg_hi:[0,1,0]
  v_pk_fma_f32 v[102:103], v[114:115], v[172:173], v[102:103] op_sel_hi:[1,0,1] neg_lo:[0,1,0] neg_hi:[0,1,0]
  v_pk_fma_f32 v[104:105], v[116:117], v[172:173], v[104:105] op_sel_hi:[1,0,1] neg_lo:[0,1,0] neg_hi:[0,1,0]
  v_pk_fma_f32 v[106:107], v[118:119], v[172:173], v[106:107] op_sel_hi:[1,0,1] neg_lo:[0,1,0] neg_hi:[0,1,0]
  v_pk_fma_f32 v[108:109], v[120:121], v[172:173], v[108:109] op_sel_hi:[1,0,1] neg_lo:[0,1,0] neg_hi:[0,1,0]
  v_pk_fma_f32 v[110:111], v[122:123], v[172:173], v[110:111] op_sel_hi:[1,0,1] neg_lo:[0,1,0] neg_hi:[0,1,0]
  v_pk_mul_f32 v[180:181], v[100:101], v[100:101]
  v_pk_mul_f32 v[182:183], v[102:103], v[102:103]
  v_pk_mul_f32 v[184:185], v[104:105], v[104:105]
  v_pk_mul_f32 v[186:187], v[106:107], v[106:107]
  v_pk_mul_f32 v[188:189], v[108:109], v[108:109]
  v_pk_mul_f32 v[190:191], v[110:111], v[110:111]
  v_pk_fma_f32 v[180:181], v[180:181], v[176:177], v[174:175] op_sel_hi:[1,0,0]
  v_pk_fma_f32 v[182:183], v[182:183], v[176:177], v[174:175] op_sel_hi:[1,0,0]
  v_pk_fma_f32 v[184:185], v[184:185], v[176:177], v[174:175] op_sel_hi:[1,0,0]
  v_pk_fma_f32 v[186:187], v[186:187], v[176:177], v[174:175] op_sel_hi:[1,0,0]
  v_pk_fma_f32 v[188:189], v[188:189], v[176:177], v[174:175] op_sel_hi:[1,0,0]
  v_pk_fma_f32 v[190:191], v[190:191], v[176:177], v[174:175] op_sel_hi:[1,0,0]
  v_pk_mul_f32 v[180:181], v[180:181], v[100:101]
  v_pk_mul_f32 v[182:183], v[182:183], v[102:103]
  v_pk_mul_f32 v[184:185], v[184:185], v[104:105]
  v_pk_mul_f32 v[186:187], v[186:187], v[106:107]
  v_pk_mul_f32 v[188:189], v[188:189], v[108:109]
  v_pk_mul_f32 v[190:191], v[190:191], v[110:111]
  v_exp_f32 v180, v180
  v_exp_f32 v181, v181
  v_exp_f32 v182, v182
  v_exp_f32 v183, v183
  v_exp_f32 v184, v184
  v_exp_f32 v185, v185
  v_exp_f32 v186, v186
  v_exp_f32 v187, v187
  v_exp_f32 v188, v188
  v_exp_f32 v189, v189
  v_exp_f32 v190, v190
  v_exp_f32 v191, v191
  v_pk_fma_f32 v[180:181], v[180:181], v[178:179], v[178:179] op_sel_hi:[1,0,0]
  v_pk_fma_f32 v[182:183], v[182:183], v[178:179], v[178:179] op_sel_hi:[1,0,0]
  v_pk_fma_f32 v[184:185], v[184:185], v[178:179], v[178:179] op_sel_hi:[1,0,0]
  v_pk_fma_f32 v[186:187], v[186:187], v[178:179], v[178:179] op_sel_hi:[1,0,0]
  v_pk_fma_f32 v[188:189], v[188:189], v[178:179], v[178:179] op_sel_hi:[1,0,0]
  v_pk_fma_f32 v[190:191], v[190:191], v[178:179], v[178:179] op_sel_hi:[1,0,0]
  v_rcp_f32 v180, v180
  v_rcp_f32 v181, v181
  v_rcp_f32 v182, v182
  v_rcp_f32 v183, v183
  v_rcp_f32 v184, v184
  v_rcp_f32 v185, v185
  v_rcp_f32 v186, v186
  v_rcp_f32 v187, v187
  v_rcp_f32 v188, v188
  v_rcp_f32 v189, v189
  v_rcp_f32 v190, v190
  v_rcp_f32 v191, v191
  v_pk_mul_f32 v[100:101], v[100:101], v[180:181]
  v_pk_mul_f32 v[102:103], v[102:103], v[182:183]
  v_pk_mul_f32 v[104:105], v[104:105], v[184:185]
  v_pk_mul_f32 v[106:107], v[106:107], v[186:187]
  v_pk_mul_f32 v[108:109], v[108:109], v[188:189]
  v_pk_mul_f32 v[110:111], v[110:111], v[190:191]
  v_cvt_pk_bf16_f32 v192, v100, v101
  v_cvt_pk_bf16_f32 v193, v102, v103
  ds_write_b64 v135, v[192:193] offset:9984
  v_cvt_pk_bf16_f32 v194, v104, v105
  v_cvt_pk_bf16_f32 v195, v106, v107
  ds_write_b64 v135, v[194:195] offset:10016
  v_cvt_pk_bf16_f32 v196, v108, v109
  v_cvt_pk_bf16_f32 v197, v110, v111
  ds_write_b64 v135, v[196:197] offset:10048
  s_waitcnt lgkmcnt(0)
  s_branch LC_p3join_19
LC_p3skip_18:
  s_barrier
  s_barrier
  s_barrier
  s_barrier
  s_barrier
  s_barrier
  s_barrier
  s_barrier
  s_barrier
  s_barrier
LC_p3join_19:
  s_barrier
  s_barrier
  ds_read_b128 v[180:183], v50 offset:32768
  ds_read_b64_tr_b16 v[188:189], v54 offset:32768
  ds_read_b64_tr_b16 v[190:191], v54 offset:33280
  ds_read_b128 v[184:187], v252 offset:32768
  ds_read_b64_tr_b16 v[192:193], v55 offset:32768
  ds_read_b64_tr_b16 v[194:195], v55 offset:33280
  ds_read_b128 v[196:199], v51 offset:32768
  ds_read_b64_tr_b16 v[204:205], v54 offset:36864
  ds_read_b64_tr_b16 v[206:207], v54 offset:37376
  ds_read_b128 v[200:203], v253 offset:32768
  ds_read_b64_tr_b16 v[208:209], v55 offset:36864
  ds_read_b64_tr_b16 v[210:211], v55 offset:37376
  s_waitcnt lgkmcnt(9)
  v_mfma_f32_16x16x32_bf16 v[32:35], v[188:191], v[180:183], v[32:35]
  ds_read_b128 v[212:215], v50 offset:40960
  ds_read_b64_tr_b16 v[220:221], v54 offset:40960
  ds_read_b64_tr_b16 v[222:223], v54 offset:41472
  s_waitcnt lgkmcnt(11)
  v_mfma_f32_16x16x32_bf16 v[40:43], v[188:191], v[184:187], v[40:43]
  ds_read_b128 v[216:219], v252 offset:40960
  ds_read_b64_tr_b16 v[224:225], v55 offset:40960
  ds_read_b64_tr_b16 v[226:227], v55 offset:41472
  s_waitcnt lgkmcnt(12)
  v_mfma_f32_16x16x32_bf16 v[36:39], v[192:195], v[180:183], v[36:39]
  ds_read_b128 v[228:231], v51 offset:40960
  ds_read_b64_tr_b16 v[236:237], v54 offset:45056
  ds_read_b64_tr_b16 v[238:239], v54 offset:45568
  v_mfma_f32_16x16x32_bf16 v[44:47], v[192:195], v[184:187], v[44:47]
  ds_read_b128 v[232:235], v253 offset:40960
  ds_read_b64_tr_b16 v[240:241], v55 offset:45056
  ds_read_b64_tr_b16 v[242:243], v55 offset:45568
  s_waitcnt lgkmcnt(15)
  v_mfma_f32_16x16x32_bf16 v[32:35], v[204:207], v[196:199], v[32:35]
  s_waitcnt lgkmcnt(14)
  v_mfma_f32_16x16x32_bf16 v[40:43], v[204:207], v[200:203], v[40:43]
  s_waitcnt lgkmcnt(12)
  v_mfma_f32_16x16x32_bf16 v[36:39], v[208:211], v[196:199], v[36:39]
  v_mfma_f32_16x16x32_bf16 v[44:47], v[208:211], v[200:203], v[44:47]
  s_waitcnt lgkmcnt(9)
  v_mfma_f32_16x16x32_bf16 v[32:35], v[220:223], v[212:215], v[32:35]
  ds_read_b128 v[180:183], v50 offset:49152
  ds_read_b64_tr_b16 v[188:189], v54 offset:49152
  ds_read_b64_tr_b16 v[190:191], v54 offset:49664
  s_waitcnt lgkmcnt(11)
  v_mfma_f32_16x16x32_bf16 v[40:43], v[220:223], v[216:219], v[40:43]
  ds_read_b128 v[184:187], v252 offset:49152
  ds_read_b64_tr_b16 v[192:193], v55 offset:49152
  ds_read_b64_tr_b16 v[194:195], v55 offset:49664
  s_waitcnt lgkmcnt(12)
  v_mfma_f32_16x16x32_bf16 v[36:39], v[224:227], v[212:215], v[36:39]
  ds_read_b128 v[196:199], v51 offset:49152
  ds_read_b64_tr_b16 v[204:205], v54 offset:53248
  ds_read_b64_tr_b16 v[206:207], v54 offset:53760
  v_mfma_f32_16x16x32_bf16 v[44:47], v[224:227], v[216:219], v[44:47]
  ds_read_b128 v[200:203], v253 offset:49152
  ds_read_b64_tr_b16 v[208:209], v55 offset:53248
  ds_read_b64_tr_b16 v[210:211], v55 offset:53760
  s_waitcnt lgkmcnt(15)
  v_mfma_f32_16x16x32_bf16 v[32:35], v[236:239], v[228:231], v[32:35]
  s_waitcnt lgkmcnt(14)
  v_mfma_f32_16x16x32_bf16 v[40:43], v[236:239], v[232:235], v[40:43]
  s_waitcnt lgkmcnt(12)
  v_mfma_f32_16x16x32_bf16 v[36:39], v[240:243], v[228:231], v[36:39]
  v_mfma_f32_16x16x32_bf16 v[44:47], v[240:243], v[232:235], v[44:47]
  s_waitcnt lgkmcnt(9)
  v_mfma_f32_16x16x32_bf16 v[32:35], v[188:191], v[180:183], v[32:35]
  ds_read_b128 v[212:215], v50 offset:57344
  ds_read_b64_tr_b16 v[220:221], v54 offset:57344
  ds_read_b64_tr_b16 v[222:223], v54 offset:57856
  s_waitcnt lgkmcnt(11)
  v_mfma_f32_16x16x32_bf16 v[40:43], v[188:191], v[184:187], v[40:43]
  ds_read_b128 v[216:219], v252 offset:57344
  ds_read_b64_tr_b16 v[224:225], v55 offset:57344
  ds_read_b64_tr_b16 v[226:227], v55 offset:57856
  s_waitcnt lgkmcnt(12)
  v_mfma_f32_16x16x32_bf16 v[36:39], v[192:195], v[180:183], v[36:39]
  ds_read_b128 v[228:231], v51 offset:57344
  ds_read_b64_tr_b16 v[236:237], v54 offset:61440
  ds_read_b64_tr_b16 v[238:239], v54 offset:61952
  v_mfma_f32_16x16x32_bf16 v[44:47], v[192:195], v[184:187], v[44:47]
  ds_read_b128 v[232:235], v253 offset:57344
  ds_read_b64_tr_b16 v[240:241], v55 offset:61440
  ds_read_b64_tr_b16 v[242:243], v55 offset:61952
  s_waitcnt lgkmcnt(15)
  v_mfma_f32_16x16x32_bf16 v[32:35], v[204:207], v[196:199], v[32:35]
  s_waitcnt lgkmcnt(14)
  v_mfma_f32_16x16x32_bf16 v[40:43], v[204:207], v[200:203], v[40:43]
  s_waitcnt lgkmcnt(12)
  v_mfma_f32_16x16x32_bf16 v[36:39], v[208:211], v[196:199], v[36:39]
  v_mfma_f32_16x16x32_bf16 v[44:47], v[208:211], v[200:203], v[44:47]
  s_waitcnt lgkmcnt(0)
  s_barrier
  v_mfma_f32_16x16x32_bf16 v[32:35], v[220:223], v[212:215], v[32:35]
  ds_read_b128 v[180:183], v52 offset:0
  ds_read_b64_tr_b16 v[188:189], v56 offset:0
  ds_read_b64_tr_b16 v[190:191], v56 offset:512
  v_mfma_f32_16x16x32_bf16 v[40:43], v[220:223], v[216:219], v[40:43]
  ds_read_b128 v[184:187], v254 offset:0
  ds_read_b64_tr_b16 v[192:193], v57 offset:0
  ds_read_b64_tr_b16 v[194:195], v57 offset:512
  v_mfma_f32_16x16x32_bf16 v[36:39], v[224:227], v[212:215], v[36:39]
  ds_read_b128 v[196:199], v53 offset:0
  ds_read_b64_tr_b16 v[204:205], v56 offset:4096
  ds_read_b64_tr_b16 v[206:207], v56 offset:4608
  v_mfma_f32_16x16x32_bf16 v[44:47], v[224:227], v[216:219], v[44:47]
  ds_read_b128 v[200:203], v255 offset:0
  ds_read_b64_tr_b16 v[208:209], v57 offset:4096
  ds_read_b64_tr_b16 v[210:211], v57 offset:4608
  v_mfma_f32_16x16x32_bf16 v[32:35], v[236:239], v[228:231], v[32:35]
  v_mfma_f32_16x16x32_bf16 v[40:43], v[236:239], v[232:235], v[40:43]
  v_mfma_f32_16x16x32_bf16 v[36:39], v[240:243], v[228:231], v[36:39]
  v_mfma_f32_16x16x32_bf16 v[44:47], v[240:243], v[232:235], v[44:47]
  s_waitcnt lgkmcnt(9)
  v_mfma_f32_16x16x32_bf16 v[32:35], v[188:191], v[180:183], v[32:35]
  ds_read_b128 v[212:215], v52 offset:8192
  ds_read_b64_tr_b16 v[220:221], v56 offset:8192
  ds_read_b64_tr_b16 v[222:223], v56 offset:8704
  s_waitcnt lgkmcnt(11)
  v_mfma_f32_16x16x32_bf16 v[40:43], v[188:191], v[184:187], v[40:43]
  ds_read_b128 v[216:219], v254 offset:8192
  ds_read_b64_tr_b16 v[224:225], v57 offset:8192
  ds_read_b64_tr_b16 v[226:227], v57 offset:8704
  s_waitcnt lgkmcnt(12)
  v_mfma_f32_16x16x32_bf16 v[36:39], v[192:195], v[180:183], v[36:39]
  ds_read_b128 v[228:231], v53 offset:8192
  ds_read_b64_tr_b16 v[236:237], v56 offset:12288
  ds_read_b64_tr_b16 v[238:239], v56 offset:12800
  v_mfma_f32_16x16x32_bf16 v[44:47], v[192:195], v[184:187], v[44:47]
  ds_read_b128 v[232:235], v255 offset:8192
  ds_read_b64_tr_b16 v[240:241], v57 offset:12288
  ds_read_b64_tr_b16 v[242:243], v57 offset:12800
  s_waitcnt lgkmcnt(15)
  v_mfma_f32_16x16x32_bf16 v[32:35], v[204:207], v[196:199], v[32:35]
  s_waitcnt lgkmcnt(14)
  v_mfma_f32_16x16x32_bf16 v[40:43], v[204:207], v[200:203], v[40:43]
  s_waitcnt lgkmcnt(12)
  v_mfma_f32_16x16x32_bf16 v[36:39], v[208:211], v[196:199], v[36:39]
  v_mfma_f32_16x16x32_bf16 v[44:47], v[208:211], v[200:203], v[44:47]
  s_waitcnt lgkmcnt(9)
  v_mfma_f32_16x16x32_bf16 v[32:35], v[220:223], v[212:215], v[32:35]
  ds_read_b128 v[180:183], v52 offset:16384
  ds_read_b64_tr_b16 v[188:189], v56 offset:16384
  ds_read_b64_tr_b16 v[190:191], v56 offset:16896
  s_waitcnt lgkmcnt(11)
  v_mfma_f32_16x16x32_bf16 v[40:43], v[220:223], v[216:219], v[40:43]
  ds_read_b128 v[184:187], v254 offset:16384
  ds_read_b64_tr_b16 v[192:193], v57 offset:16384
  ds_read_b64_tr_b16 v[194:195], v57 offset:16896
  s_waitcnt lgkmcnt(12)
  v_mfma_f32_16x16x32_bf16 v[36:39], v[224:227], v[212:215], v[36:39]
  ds_read_b128 v[196:199], v53 offset:16384
  ds_read_b64_tr_b16 v[204:205], v56 offset:20480
  ds_read_b64_tr_b16 v[206:207], v56 offset:20992
  v_mfma_f32_16x16x32_bf16 v[44:47], v[224:227], v[216:219], v[44:47]
  ds_read_b128 v[200:203], v255 offset:16384
  ds_read_b64_tr_b16 v[208:209], v57 offset:20480
  ds_read_b64_tr_b16 v[210:211], v57 offset:20992
  s_waitcnt lgkmcnt(15)
  v_mfma_f32_16x16x32_bf16 v[32:35], v[236:239], v[228:231], v[32:35]
  s_waitcnt lgkmcnt(14)
  v_mfma_f32_16x16x32_bf16 v[40:43], v[236:239], v[232:235], v[40:43]
  s_waitcnt lgkmcnt(12)
  v_mfma_f32_16x16x32_bf16 v[36:39], v[240:243], v[228:231], v[36:39]
  v_mfma_f32_16x16x32_bf16 v[44:47], v[240:243], v[232:235], v[44:47]
  s_waitcnt lgkmcnt(9)
  v_mfma_f32_16x16x32_bf16 v[32:35], v[188:191], v[180:183], v[32:35]
  ds_read_b128 v[212:215], v52 offset:24576
  ds_read_b64_tr_b16 v[220:221], v56 offset:24576
  ds_read_b64_tr_b16 v[222:223], v56 offset:25088
  s_waitcnt lgkmcnt(11)
  v_mfma_f32_16x16x32_bf16 v[40:43], v[188:191], v[184:187], v[40:43]
  ds_read_b128 v[216:219], v254 offset:24576
  ds_read_b64_tr_b16 v[224:225], v57 offset:24576
  ds_read_b64_tr_b16 v[226:227], v57 offset:25088
  s_waitcnt lgkmcnt(12)
  v_mfma_f32_16x16x32_bf16 v[36:39], v[192:195], v[180:183], v[36:39]
  ds_read_b128 v[228:231], v53 offset:24576
  ds_read_b64_tr_b16 v[236:237], v56 offset:28672
  ds_read_b64_tr_b16 v[238:239], v56 offset:29184
  v_mfma_f32_16x16x32_bf16 v[44:47], v[192:195], v[184:187], v[44:47]
  ds_read_b128 v[232:235], v255 offset:24576
  ds_read_b64_tr_b16 v[240:241], v57 offset:28672
  ds_read_b64_tr_b16 v[242:243], v57 offset:29184
  s_waitcnt lgkmcnt(15)
  v_mfma_f32_16x16x32_bf16 v[32:35], v[204:207], v[196:199], v[32:35]
  s_waitcnt lgkmcnt(14)
  v_mfma_f32_16x16x32_bf16 v[40:43], v[204:207], v[200:203], v[40:43]
  s_waitcnt lgkmcnt(12)
  v_mfma_f32_16x16x32_bf16 v[36:39], v[208:211], v[196:199], v[36:39]
  v_mfma_f32_16x16x32_bf16 v[44:47], v[208:211], v[200:203], v[44:47]
  s_waitcnt lgkmcnt(9)
  v_mfma_f32_16x16x32_bf16 v[32:35], v[220:223], v[212:215], v[32:35]
  s_waitcnt lgkmcnt(8)
  v_mfma_f32_16x16x32_bf16 v[40:43], v[220:223], v[216:219], v[40:43]
  s_waitcnt lgkmcnt(6)
  v_mfma_f32_16x16x32_bf16 v[36:39], v[224:227], v[212:215], v[36:39]
  v_mfma_f32_16x16x32_bf16 v[44:47], v[224:227], v[216:219], v[44:47]
  s_waitcnt lgkmcnt(3)
  v_mfma_f32_16x16x32_bf16 v[32:35], v[236:239], v[228:231], v[32:35]
  s_waitcnt lgkmcnt(2)
  v_mfma_f32_16x16x32_bf16 v[40:43], v[236:239], v[232:235], v[40:43]
  s_waitcnt lgkmcnt(0)
  v_mfma_f32_16x16x32_bf16 v[36:39], v[240:243], v[228:231], v[36:39]
  v_mfma_f32_16x16x32_bf16 v[44:47], v[240:243], v[232:235], v[44:47]
  s_barrier
  s_cmp_eq_u32 s48, 0
  s_cbranch_scc0 LC_p5_20
  s_add_u32 s74, s49, 5
  s_mov_b32 s75, 0
LC_pl_21:
  buffer_load_dwordx4 v[144:147], v138, s[36:39], 0 offen sc1
  s_waitcnt vmcnt(0)
LC_pk_23:
  v_subrev_u32 v144, s74, v144
  v_subrev_u32 v145, s74, v145
  v_subrev_u32 v146, s74, v146
  v_subrev_u32 v147, s74, v147
  v_max3_u32 v4, v144, v145, v146
  v_max_u32 v4, v4, v147
  v_cmp_ge_u32 vcc, 2, v4
  s_add_u32 s75, s75, 1
  s_nop 2
  s_cmp_eq_u64 vcc, exec
  s_cbranch_scc1 LC_pd_22
  s_cmp_lt_u32 s75, 400000
  s_cbranch_scc1 LC_pl_21
LC_pd_22:
LC_p5_20:
  s_barrier
  s_barrier
  ds_read_b128 v[180:183], v50 offset:16384
  ds_read_b64_tr_b16 v[188:189], v54 offset:0
  ds_read_b64_tr_b16 v[190:191], v54 offset:512
  ds_read_b128 v[184:187], v252 offset:16384
  ds_read_b64_tr_b16 v[192:193], v55 offset:0
  ds_read_b64_tr_b16 v[194:195], v55 offset:512
  ds_read_b128 v[196:199], v51 offset:16384
  ds_read_b64_tr_b16 v[204:205], v54 offset:4096
  ds_read_b64_tr_b16 v[206:207], v54 offset:4608
  ds_read_b128 v[200:203], v253 offset:16384
  ds_read_b64_tr_b16 v[208:209], v55 offset:4096
  ds_read_b64_tr_b16 v[210:211], v55 offset:4608
  s_waitcnt lgkmcnt(9)
  v_mfma_f32_16x16x32_bf16 v[32:35], v[188:191], v[180:183], v[32:35]
  ds_read_b128 v[212:215], v50 offset:24576
  ds_read_b64_tr_b16 v[220:221], v54 offset:8192
  ds_read_b64_tr_b16 v[222:223], v54 offset:8704
  s_waitcnt lgkmcnt(11)
  v_mfma_f32_16x16x32_bf16 v[40:43], v[188:191], v[184:187], v[40:43]
  ds_read_b128 v[216:219], v252 offset:24576
  ds_read_b64_tr_b16 v[224:225], v55 offset:8192
  ds_read_b64_tr_b16 v[226:227], v55 offset:8704
  s_waitcnt lgkmcnt(12)
  v_mfma_f32_16x16x32_bf16 v[36:39], v[192:195], v[180:183], v[36:39]
  ds_read_b128 v[228:231], v51 offset:24576
  ds_read_b64_tr_b16 v[236:237], v54 offset:12288
  ds_read_b64_tr_b16 v[238:239], v54 offset:12800
  v_mfma_f32_16x16x32_bf16 v[44:47], v[192:195], v[184:187], v[44:47]
  ds_read_b128 v[232:235], v253 offset:24576
  ds_read_b64_tr_b16 v[240:241], v55 offset:12288
  ds_read_b64_tr_b16 v[242:243], v55 offset:12800
  s_waitcnt lgkmcnt(15)
  v_mfma_f32_16x16x32_bf16 v[32:35], v[204:207], v[196:199], v[32:35]
  s_waitcnt lgkmcnt(14)
  v_mfma_f32_16x16x32_bf16 v[40:43], v[204:207], v[200:203], v[40:43]
  s_waitcnt lgkmcnt(12)
  v_mfma_f32_16x16x32_bf16 v[36:39], v[208:211], v[196:199], v[36:39]
  v_mfma_f32_16x16x32_bf16 v[44:47], v[208:211], v[200:203], v[44:47]
  s_waitcnt lgkmcnt(0)
  s_barrier
  v_mfma_f32_16x16x32_bf16 v[32:35], v[220:223], v[212:215], v[32:35]
  ds_read_b128 v[180:183], v52 offset:0
  ds_read_b64_tr_b16 v[188:189], v54 offset:16384
  ds_read_b64_tr_b16 v[190:191], v54 offset:16896
  v_mfma_f32_16x16x32_bf16 v[40:43], v[220:223], v[216:219], v[40:43]
  ds_read_b128 v[184:187], v254 offset:0
  ds_read_b64_tr_b16 v[192:193], v55 offset:16384
  ds_read_b64_tr_b16 v[194:195], v55 offset:16896
  v_mfma_f32_16x16x32_bf16 v[36:39], v[224:227], v[212:215], v[36:39]
  ds_read_b128 v[196:199], v53 offset:0
  ds_read_b64_tr_b16 v[204:205], v54 offset:20480
  ds_read_b64_tr_b16 v[206:207], v54 offset:20992
  v_mfma_f32_16x16x32_bf16 v[44:47], v[224:227], v[216:219], v[44:47]
  ds_read_b128 v[200:203], v255 offset:0
  ds_read_b64_tr_b16 v[208:209], v55 offset:20480
  ds_read_b64_tr_b16 v[210:211], v55 offset:20992
  v_mfma_f32_16x16x32_bf16 v[32:35], v[236:239], v[228:231], v[32:35]
  v_mfma_f32_16x16x32_bf16 v[40:43], v[236:239], v[232:235], v[40:43]
  v_mfma_f32_16x16x32_bf16 v[36:39], v[240:243], v[228:231], v[36:39]
  v_mfma_f32_16x16x32_bf16 v[44:47], v[240:243], v[232:235], v[44:47]
  s_waitcnt lgkmcnt(9)
  v_mfma_f32_16x16x32_bf16 v[32:35], v[188:191], v[180:183], v[32:35]
  ds_read_b128 v[212:215], v52 offset:8192
  ds_read_b64_tr_b16 v[220:221], v54 offset:24576
  ds_read_b64_tr_b16 v[222:223], v54 offset:25088
  s_waitcnt lgkmcnt(11)
  v_mfma_f32_16x16x32_bf16 v[40:43], v[188:191], v[184:187], v[40:43]
  ds_read_b128 v[216:219], v254 offset:8192
  ds_read_b64_tr_b16 v[224:225], v55 offset:24576
  ds_read_b64_tr_b16 v[226:227], v55 offset:25088
  s_waitcnt lgkmcnt(12)
  v_mfma_f32_16x16x32_bf16 v[36:39], v[192:195], v[180:183], v[36:39]
  ds_read_b128 v[228:231], v53 offset:8192
  ds_read_b64_tr_b16 v[236:237], v54 offset:28672
  ds_read_b64_tr_b16 v[238:239], v54 offset:29184
  v_mfma_f32_16x16x32_bf16 v[44:47], v[192:195], v[184:187], v[44:47]
  ds_read_b128 v[232:235], v255 offset:8192
  ds_read_b64_tr_b16 v[240:241], v55 offset:28672
  ds_read_b64_tr_b16 v[242:243], v55 offset:29184
  s_waitcnt lgkmcnt(15)
  v_mfma_f32_16x16x32_bf16 v[32:35], v[204:207], v[196:199], v[32:35]
  s_waitcnt lgkmcnt(14)
  v_mfma_f32_16x16x32_bf16 v[40:43], v[204:207], v[200:203], v[40:43]
  s_waitcnt lgkmcnt(12)
  v_mfma_f32_16x16x32_bf16 v[36:39], v[208:211], v[196:199], v[36:39]
  v_mfma_f32_16x16x32_bf16 v[44:47], v[208:211], v[200:203], v[44:47]
  s_waitcnt lgkmcnt(0)
  s_barrier
  v_mfma_f32_16x16x32_bf16 v[32:35], v[220:223], v[212:215], v[32:35]
  ds_read_b128 v[180:183], v52 offset:16384
  ds_read_b64_tr_b16 v[188:189], v54 offset:32768
  ds_read_b64_tr_b16 v[190:191], v54 offset:33280
  v_mfma_f32_16x16x32_bf16 v[40:43], v[220:223], v[216:219], v[40:43]
  ds_read_b128 v[184:187], v254 offset:16384
  ds_read_b64_tr_b16 v[192:193], v55 offset:32768
  ds_read_b64_tr_b16 v[194:195], v55 offset:33280
  v_mfma_f32_16x16x32_bf16 v[36:39], v[224:227], v[212:215], v[36:39]
  ds_read_b128 v[196:199], v53 offset:16384
  ds_read_b64_tr_b16 v[204:205], v54 offset:36864
  ds_read_b64_tr_b16 v[206:207], v54 offset:37376
  v_mfma_f32_16x16x32_bf16 v[44:47], v[224:227], v[216:219], v[44:47]
  ds_read_b128 v[200:203], v255 offset:16384
  ds_read_b64_tr_b16 v[208:209], v55 offset:36864
  ds_read_b64_tr_b16 v[210:211], v55 offset:37376
  v_mfma_f32_16x16x32_bf16 v[32:35], v[236:239], v[228:231], v[32:35]
  v_mfma_f32_16x16x32_bf16 v[40:43], v[236:239], v[232:235], v[40:43]
  v_mfma_f32_16x16x32_bf16 v[36:39], v[240:243], v[228:231], v[36:39]
  v_mfma_f32_16x16x32_bf16 v[44:47], v[240:243], v[232:235], v[44:47]
  s_waitcnt lgkmcnt(9)
  v_mfma_f32_16x16x32_bf16 v[32:35], v[188:191], v[180:183], v[32:35]
  ds_read_b128 v[212:215], v52 offset:24576
  ds_read_b64_tr_b16 v[220:221], v54 offset:40960
  ds_read_b64_tr_b16 v[222:223], v54 offset:41472
  s_waitcnt lgkmcnt(11)
  v_mfma_f32_16x16x32_bf16 v[40:43], v[188:191], v[184:187], v[40:43]
  ds_read_b128 v[216:219], v254 offset:24576
  ds_read_b64_tr_b16 v[224:225], v55 offset:40960
  ds_read_b64_tr_b16 v[226:227], v55 offset:41472
  s_waitcnt lgkmcnt(12)
  v_mfma_f32_16x16x32_bf16 v[36:39], v[192:195], v[180:183], v[36:39]
  ds_read_b128 v[228:231], v53 offset:24576
  ds_read_b64_tr_b16 v[236:237], v54 offset:45056
  ds_read_b64_tr_b16 v[238:239], v54 offset:45568
  v_mfma_f32_16x16x32_bf16 v[44:47], v[192:195], v[184:187], v[44:47]
  ds_read_b128 v[232:235], v255 offset:24576
  ds_read_b64_tr_b16 v[240:241], v55 offset:45056
  ds_read_b64_tr_b16 v[242:243], v55 offset:45568
  s_waitcnt lgkmcnt(15)
  v_mfma_f32_16x16x32_bf16 v[32:35], v[204:207], v[196:199], v[32:35]
  s_waitcnt lgkmcnt(14)
  v_mfma_f32_16x16x32_bf16 v[40:43], v[204:207], v[200:203], v[40:43]
  s_waitcnt lgkmcnt(12)
  v_mfma_f32_16x16x32_bf16 v[36:39], v[208:211], v[196:199], v[36:39]
  v_mfma_f32_16x16x32_bf16 v[44:47], v[208:211], v[200:203], v[44:47]
  s_waitcnt lgkmcnt(0)
  s_barrier
  v_mfma_f32_16x16x32_bf16 v[32:35], v[220:223], v[212:215], v[32:35]
  ds_read_b128 v[180:183], v50 offset:16384
  ds_read_b64_tr_b16 v[188:189], v54 offset:49152
  ds_read_b64_tr_b16 v[190:191], v54 offset:49664
  v_mfma_f32_16x16x32_bf16 v[40:43], v[220:223], v[216:219], v[40:43]
  ds_read_b128 v[184:187], v252 offset:16384
  ds_read_b64_tr_b16 v[192:193], v55 offset:49152
  ds_read_b64_tr_b16 v[194:195], v55 offset:49664
  v_mfma_f32_16x16x32_bf16 v[36:39], v[224:227], v[212:215], v[36:39]
  ds_read_b128 v[196:199], v51 offset:16384
  ds_read_b64_tr_b16 v[204:205], v54 offset:53248
  ds_read_b64_tr_b16 v[206:207], v54 offset:53760
  v_mfma_f32_16x16x32_bf16 v[44:47], v[224:227], v[216:219], v[44:47]
  ds_read_b128 v[200:203], v253 offset:16384
  ds_read_b64_tr_b16 v[208:209], v55 offset:53248
  ds_read_b64_tr_b16 v[210:211], v55 offset:53760
  v_mfma_f32_16x16x32_bf16 v[32:35], v[236:239], v[228:231], v[32:35]
  v_mfma_f32_16x16x32_bf16 v[40:43], v[236:239], v[232:235], v[40:43]
  v_mfma_f32_16x16x32_bf16 v[36:39], v[240:243], v[228:231], v[36:39]
  v_mfma_f32_16x16x32_bf16 v[44:47], v[240:243], v[232:235], v[44:47]
  s_waitcnt lgkmcnt(9)
  v_mfma_f32_16x16x32_bf16 v[32:35], v[188:191], v[180:183], v[32:35]
  ds_read_b128 v[212:215], v48 offset:0
  ds_read_b64_tr_b16 v[220:221], v54 offset:57344
  ds_read_b64_tr_b16 v[222:223], v54 offset:57856
  s_waitcnt lgkmcnt(11)
  v_mfma_f32_16x16x32_bf16 v[40:43], v[188:191], v[184:187], v[40:43]
  ds_read_b128 v[216:219], v142 offset:0
  ds_read_b64_tr_b16 v[224:225], v55 offset:57344
  ds_read_b64_tr_b16 v[226:227], v55 offset:57856
  s_waitcnt lgkmcnt(12)
  v_mfma_f32_16x16x32_bf16 v[36:39], v[192:195], v[180:183], v[36:39]
  ds_read_b128 v[228:231], v49 offset:0
  ds_read_b64_tr_b16 v[236:237], v54 offset:61440
  ds_read_b64_tr_b16 v[238:239], v54 offset:61952
  v_mfma_f32_16x16x32_bf16 v[44:47], v[192:195], v[184:187], v[44:47]
  ds_read_b128 v[232:235], v143 offset:0
  ds_read_b64_tr_b16 v[240:241], v55 offset:61440
  ds_read_b64_tr_b16 v[242:243], v55 offset:61952
  s_waitcnt lgkmcnt(15)
  v_mfma_f32_16x16x32_bf16 v[32:35], v[204:207], v[196:199], v[32:35]
  s_waitcnt lgkmcnt(14)
  v_mfma_f32_16x16x32_bf16 v[40:43], v[204:207], v[200:203], v[40:43]
  s_waitcnt lgkmcnt(12)
  v_mfma_f32_16x16x32_bf16 v[36:39], v[208:211], v[196:199], v[36:39]
  v_mfma_f32_16x16x32_bf16 v[44:47], v[208:211], v[200:203], v[44:47]
  s_waitcnt lgkmcnt(0)
  s_barrier
  v_mfma_f32_16x16x32_bf16 v[32:35], v[220:223], v[212:215], v[32:35]
  ds_read_b128 v[180:183], v50 offset:24576
  ds_read_b64_tr_b16 v[188:189], v56 offset:32768
  ds_read_b64_tr_b16 v[190:191], v56 offset:33280
  v_mfma_f32_16x16x32_bf16 v[40:43], v[220:223], v[216:219], v[40:43]
  ds_read_b128 v[184:187], v252 offset:24576
  ds_read_b64_tr_b16 v[192:193], v57 offset:32768
  ds_read_b64_tr_b16 v[194:195], v57 offset:33280
  v_mfma_f32_16x16x32_bf16 v[36:39], v[224:227], v[212:215], v[36:39]
  ds_read_b128 v[196:199], v51 offset:24576
  ds_read_b64_tr_b16 v[204:205], v56 offset:36864
  ds_read_b64_tr_b16 v[206:207], v56 offset:37376
  v_mfma_f32_16x16x32_bf16 v[44:47], v[224:227], v[216:219], v[44:47]
  ds_read_b128 v[200:203], v253 offset:24576
  ds_read_b64_tr_b16 v[208:209], v57 offset:36864
  ds_read_b64_tr_b16 v[210:211], v57 offset:37376
  v_mfma_f32_16x16x32_bf16 v[32:35], v[236:239], v[228:231], v[32:35]
  v_mfma_f32_16x16x32_bf16 v[40:43], v[236:239], v[232:235], v[40:43]
  v_mfma_f32_16x16x32_bf16 v[36:39], v[240:243], v[228:231], v[36:39]
  v_mfma_f32_16x16x32_bf16 v[44:47], v[240:243], v[232:235], v[44:47]
  s_waitcnt lgkmcnt(9)
  v_mfma_f32_16x16x32_bf16 v[32:35], v[188:191], v[180:183], v[32:35]
  ds_read_b128 v[212:215], v48 offset:8192
  ds_read_b64_tr_b16 v[220:221], v56 offset:40960
  ds_read_b64_tr_b16 v[222:223], v56 offset:41472
  s_waitcnt lgkmcnt(11)
  v_mfma_f32_16x16x32_bf16 v[40:43], v[188:191], v[184:187], v[40:43]
  ds_read_b128 v[216:219], v142 offset:8192
  ds_read_b64_tr_b16 v[224:225], v57 offset:40960
  ds_read_b64_tr_b16 v[226:227], v57 offset:41472
  s_waitcnt lgkmcnt(12)
  v_mfma_f32_16x16x32_bf16 v[36:39], v[192:195], v[180:183], v[36:39]
  ds_read_b128 v[228:231], v49 offset:8192
  ds_read_b64_tr_b16 v[236:237], v56 offset:45056
  ds_read_b64_tr_b16 v[238:239], v56 offset:45568
  v_mfma_f32_16x16x32_bf16 v[44:47], v[192:195], v[184:187], v[44:47]
  ds_read_b128 v[232:235], v143 offset:8192
  ds_read_b64_tr_b16 v[240:241], v57 offset:45056
  ds_read_b64_tr_b16 v[242:243], v57 offset:45568
  s_waitcnt lgkmcnt(15)
  v_mfma_f32_16x16x32_bf16 v[32:35], v[204:207], v[196:199], v[32:35]
  s_waitcnt lgkmcnt(14)
  v_mfma_f32_16x16x32_bf16 v[40:43], v[204:207], v[200:203], v[40:43]
  s_waitcnt lgkmcnt(12)
  v_mfma_f32_16x16x32_bf16 v[36:39], v[208:211], v[196:199], v[36:39]
  v_mfma_f32_16x16x32_bf16 v[44:47], v[208:211], v[200:203], v[44:47]
  s_waitcnt lgkmcnt(0)
  s_barrier
  v_mfma_f32_16x16x32_bf16 v[32:35], v[220:223], v[212:215], v[32:35]
  ds_read_b128 v[180:183], v52 offset:0
  ds_read_b64_tr_b16 v[188:189], v56 offset:49152
  ds_read_b64_tr_b16 v[190:191], v56 offset:49664
  v_mfma_f32_16x16x32_bf16 v[40:43], v[220:223], v[216:219], v[40:43]
  ds_read_b128 v[184:187], v254 offset:0
  ds_read_b64_tr_b16 v[192:193], v57 offset:49152
  ds_read_b64_tr_b16 v[194:195], v57 offset:49664
  v_mfma_f32_16x16x32_bf16 v[36:39], v[224:227], v[212:215], v[36:39]
  ds_read_b128 v[196:199], v53 offset:0
  ds_read_b64_tr_b16 v[204:205], v56 offset:53248
  ds_read_b64_tr_b16 v[206:207], v56 offset:53760
  v_mfma_f32_16x16x32_bf16 v[44:47], v[224:227], v[216:219], v[44:47]
  ds_read_b128 v[200:203], v255 offset:0
  ds_read_b64_tr_b16 v[208:209], v57 offset:53248
  ds_read_b64_tr_b16 v[210:211], v57 offset:53760
  v_mfma_f32_16x16x32_bf16 v[32:35], v[236:239], v[228:231], v[32:35]
  v_mfma_f32_16x16x32_bf16 v[40:43], v[236:239], v[232:235], v[40:43]
  v_mfma_f32_16x16x32_bf16 v[36:39], v[240:243], v[228:231], v[36:39]
  v_mfma_f32_16x16x32_bf16 v[44:47], v[240:243], v[232:235], v[44:47]
  s_waitcnt lgkmcnt(9)
  v_mfma_f32_16x16x32_bf16 v[32:35], v[188:191], v[180:183], v[32:35]
  ds_read_b128 v[212:215], v48 offset:16384
  ds_read_b64_tr_b16 v[220:221], v56 offset:57344
  ds_read_b64_tr_b16 v[222:223], v56 offset:57856
  s_waitcnt lgkmcnt(11)
  v_mfma_f32_16x16x32_bf16 v[40:43], v[188:191], v[184:187], v[40:43]
  ds_read_b128 v[216:219], v142 offset:16384
  ds_read_b64_tr_b16 v[224:225], v57 offset:57344
  ds_read_b64_tr_b16 v[226:227], v57 offset:57856
  s_waitcnt lgkmcnt(12)
  v_mfma_f32_16x16x32_bf16 v[36:39], v[192:195], v[180:183], v[36:39]
  ds_read_b128 v[228:231], v49 offset:16384
  ds_read_b64_tr_b16 v[236:237], v56 offset:61440
  ds_read_b64_tr_b16 v[238:239], v56 offset:61952
  v_mfma_f32_16x16x32_bf16 v[44:47], v[192:195], v[184:187], v[44:47]
  ds_read_b128 v[232:235], v143 offset:16384
  ds_read_b64_tr_b16 v[240:241], v57 offset:61440
  ds_read_b64_tr_b16 v[242:243], v57 offset:61952
  s_waitcnt lgkmcnt(15)
  v_mfma_f32_16x16x32_bf16 v[32:35], v[204:207], v[196:199], v[32:35]
  s_waitcnt lgkmcnt(14)
  v_mfma_f32_16x16x32_bf16 v[40:43], v[204:207], v[200:203], v[40:43]
  s_waitcnt lgkmcnt(12)
  v_mfma_f32_16x16x32_bf16 v[36:39], v[208:211], v[196:199], v[36:39]
  v_mfma_f32_16x16x32_bf16 v[44:47], v[208:211], v[200:203], v[44:47]
  s_waitcnt lgkmcnt(0)
  s_barrier
  v_mfma_f32_16x16x32_bf16 v[32:35], v[220:223], v[212:215], v[32:35]
  ds_read_b128 v[180:183], v52 offset:8192
  ds_read_b64_tr_b16 v[188:189], v56 offset:0
  ds_read_b64_tr_b16 v[190:191], v56 offset:512
  v_mfma_f32_16x16x32_bf16 v[40:43], v[220:223], v[216:219], v[40:43]
  ds_read_b128 v[184:187], v254 offset:8192
  ds_read_b64_tr_b16 v[192:193], v57 offset:0
  ds_read_b64_tr_b16 v[194:195], v57 offset:512
  v_mfma_f32_16x16x32_bf16 v[36:39], v[224:227], v[212:215], v[36:39]
  ds_read_b128 v[196:199], v53 offset:8192
  ds_read_b64_tr_b16 v[204:205], v56 offset:4096
  ds_read_b64_tr_b16 v[206:207], v56 offset:4608
  v_mfma_f32_16x16x32_bf16 v[44:47], v[224:227], v[216:219], v[44:47]
  ds_read_b128 v[200:203], v255 offset:8192
  ds_read_b64_tr_b16 v[208:209], v57 offset:4096
  ds_read_b64_tr_b16 v[210:211], v57 offset:4608
  v_mfma_f32_16x16x32_bf16 v[32:35], v[236:239], v[228:231], v[32:35]
  v_mfma_f32_16x16x32_bf16 v[40:43], v[236:239], v[232:235], v[40:43]
  v_mfma_f32_16x16x32_bf16 v[36:39], v[240:243], v[228:231], v[36:39]
  v_mfma_f32_16x16x32_bf16 v[44:47], v[240:243], v[232:235], v[44:47]
  s_waitcnt lgkmcnt(9)
  v_mfma_f32_16x16x32_bf16 v[32:35], v[188:191], v[180:183], v[32:35]
  ds_read_b128 v[212:215], v48 offset:24576
  ds_read_b64_tr_b16 v[220:221], v56 offset:8192
  ds_read_b64_tr_b16 v[222:223], v56 offset:8704
  s_waitcnt lgkmcnt(11)
  v_mfma_f32_16x16x32_bf16 v[40:43], v[188:191], v[184:187], v[40:43]
  ds_read_b128 v[216:219], v142 offset:24576
  ds_read_b64_tr_b16 v[224:225], v57 offset:8192
  ds_read_b64_tr_b16 v[226:227], v57 offset:8704
  s_waitcnt lgkmcnt(12)
  v_mfma_f32_16x16x32_bf16 v[36:39], v[192:195], v[180:183], v[36:39]
  ds_read_b128 v[228:231], v49 offset:24576
  ds_read_b64_tr_b16 v[236:237], v56 offset:12288
  ds_read_b64_tr_b16 v[238:239], v56 offset:12800
  v_mfma_f32_16x16x32_bf16 v[44:47], v[192:195], v[184:187], v[44:47]
  ds_read_b128 v[232:235], v143 offset:24576
  ds_read_b64_tr_b16 v[240:241], v57 offset:12288
  ds_read_b64_tr_b16 v[242:243], v57 offset:12800
  s_waitcnt lgkmcnt(15)
  v_mfma_f32_16x16x32_bf16 v[32:35], v[204:207], v[196:199], v[32:35]
  s_waitcnt lgkmcnt(14)
  v_mfma_f32_16x16x32_bf16 v[40:43], v[204:207], v[200:203], v[40:43]
  s_waitcnt lgkmcnt(12)
  v_mfma_f32_16x16x32_bf16 v[36:39], v[208:211], v[196:199], v[36:39]
  v_mfma_f32_16x16x32_bf16 v[44:47], v[208:211], v[200:203], v[44:47]
  s_waitcnt lgkmcnt(0)
  s_barrier
  v_mfma_f32_16x16x32_bf16 v[32:35], v[220:223], v[212:215], v[32:35]
  ds_read_b128 v[180:183], v52 offset:16384
  ds_read_b64_tr_b16 v[188:189], v54 offset:32768
  ds_read_b64_tr_b16 v[190:191], v54 offset:33280
  v_mfma_f32_16x16x32_bf16 v[40:43], v[220:223], v[216:219], v[40:43]
  ds_read_b128 v[184:187], v254 offset:16384
  ds_read_b64_tr_b16 v[192:193], v55 offset:32768
  ds_read_b64_tr_b16 v[194:195], v55 offset:33280
  v_mfma_f32_16x16x32_bf16 v[36:39], v[224:227], v[212:215], v[36:39]
  ds_read_b128 v[196:199], v53 offset:16384
  ds_read_b64_tr_b16 v[204:205], v54 offset:36864
  ds_read_b64_tr_b16 v[206:207], v54 offset:37376
  v_mfma_f32_16x16x32_bf16 v[44:47], v[224:227], v[216:219], v[44:47]
  ds_read_b128 v[200:203], v255 offset:16384
  ds_read_b64_tr_b16 v[208:209], v55 offset:36864
  ds_read_b64_tr_b16 v[210:211], v55 offset:37376
  v_mfma_f32_16x16x32_bf16 v[32:35], v[236:239], v[228:231], v[32:35]
  v_mfma_f32_16x16x32_bf16 v[40:43], v[236:239], v[232:235], v[40:43]
  v_mfma_f32_16x16x32_bf16 v[36:39], v[240:243], v[228:231], v[36:39]
  v_mfma_f32_16x16x32_bf16 v[44:47], v[240:243], v[232:235], v[44:47]
  s_waitcnt lgkmcnt(9)
  v_mfma_f32_16x16x32_bf16 v[32:35], v[188:191], v[180:183], v[32:35]
  ds_read_b128 v[212:215], v52 offset:24576
  ds_read_b64_tr_b16 v[220:221], v54 offset:40960
  ds_read_b64_tr_b16 v[222:223], v54 offset:41472
  s_waitcnt lgkmcnt(11)
  v_mfma_f32_16x16x32_bf16 v[40:43], v[188:191], v[184:187], v[40:43]
  ds_read_b128 v[216:219], v254 offset:24576
  ds_read_b64_tr_b16 v[224:225], v55 offset:40960
  ds_read_b64_tr_b16 v[226:227], v55 offset:41472
  s_waitcnt lgkmcnt(12)
  v_mfma_f32_16x16x32_bf16 v[36:39], v[192:195], v[180:183], v[36:39]
  ds_read_b128 v[228:231], v53 offset:24576
  ds_read_b64_tr_b16 v[236:237], v54 offset:45056
  ds_read_b64_tr_b16 v[238:239], v54 offset:45568
  v_mfma_f32_16x16x32_bf16 v[44:47], v[192:195], v[184:187], v[44:47]
  ds_read_b128 v[232:235], v255 offset:24576
  ds_read_b64_tr_b16 v[240:241], v55 offset:45056
  ds_read_b64_tr_b16 v[242:243], v55 offset:45568
  s_waitcnt lgkmcnt(15)
  v_mfma_f32_16x16x32_bf16 v[32:35], v[204:207], v[196:199], v[32:35]
  s_waitcnt lgkmcnt(14)
  v_mfma_f32_16x16x32_bf16 v[40:43], v[204:207], v[200:203], v[40:43]
  s_waitcnt lgkmcnt(12)
  v_mfma_f32_16x16x32_bf16 v[36:39], v[208:211], v[196:199], v[36:39]
  v_mfma_f32_16x16x32_bf16 v[44:47], v[208:211], v[200:203], v[44:47]
  s_waitcnt lgkmcnt(0)
  s_barrier
  v_mfma_f32_16x16x32_bf16 v[32:35], v[220:223], v[212:215], v[32:35]
  ds_read_b128 v[180:183], v50 offset:16384
  ds_read_b64_tr_b16 v[188:189], v54 offset:49152
  ds_read_b64_tr_b16 v[190:191], v54 offset:49664
  v_mfma_f32_16x16x32_bf16 v[40:43], v[220:223], v[216:219], v[40:43]
  ds_read_b128 v[184:187], v252 offset:16384
  ds_read_b64_tr_b16 v[192:193], v55 offset:49152
  ds_read_b64_tr_b16 v[194:195], v55 offset:49664
  v_mfma_f32_16x16x32_bf16 v[36:39], v[224:227], v[212:215], v[36:39]
  ds_read_b128 v[196:199], v51 offset:16384
  ds_read_b64_tr_b16 v[204:205], v54 offset:53248
  ds_read_b64_tr_b16 v[206:207], v54 offset:53760
  v_mfma_f32_16x16x32_bf16 v[44:47], v[224:227], v[216:219], v[44:47]
  ds_read_b128 v[200:203], v253 offset:16384
  ds_read_b64_tr_b16 v[208:209], v55 offset:53248
  ds_read_b64_tr_b16 v[210:211], v55 offset:53760
  v_mfma_f32_16x16x32_bf16 v[32:35], v[236:239], v[228:231], v[32:35]
  v_mfma_f32_16x16x32_bf16 v[40:43], v[236:239], v[232:235], v[40:43]
  v_mfma_f32_16x16x32_bf16 v[36:39], v[240:243], v[228:231], v[36:39]
  v_mfma_f32_16x16x32_bf16 v[44:47], v[240:243], v[232:235], v[44:47]
  s_waitcnt lgkmcnt(9)
  v_mfma_f32_16x16x32_bf16 v[32:35], v[188:191], v[180:183], v[32:35]
  ds_read_b128 v[212:215], v48 offset:0
  ds_read_b64_tr_b16 v[220:221], v54 offset:57344
  ds_read_b64_tr_b16 v[222:223], v54 offset:57856
  s_waitcnt lgkmcnt(11)
  v_mfma_f32_16x16x32_bf16 v[40:43], v[188:191], v[184:187], v[40:43]
  ds_read_b128 v[216:219], v142 offset:0
  ds_read_b64_tr_b16 v[224:225], v55 offset:57344
  ds_read_b64_tr_b16 v[226:227], v55 offset:57856
  s_waitcnt lgkmcnt(12)
  v_mfma_f32_16x16x32_bf16 v[36:39], v[192:195], v[180:183], v[36:39]
  ds_read_b128 v[228:231], v49 offset:0
  ds_read_b64_tr_b16 v[236:237], v54 offset:61440
  ds_read_b64_tr_b16 v[238:239], v54 offset:61952
  v_mfma_f32_16x16x32_bf16 v[44:47], v[192:195], v[184:187], v[44:47]
  ds_read_b128 v[232:235], v143 offset:0
  ds_read_b64_tr_b16 v[240:241], v55 offset:61440
  ds_read_b64_tr_b16 v[242:243], v55 offset:61952
  s_waitcnt lgkmcnt(15)
  v_mfma_f32_16x16x32_bf16 v[32:35], v[204:207], v[196:199], v[32:35]
  s_waitcnt lgkmcnt(14)
  v_mfma_f32_16x16x32_bf16 v[40:43], v[204:207], v[200:203], v[40:43]
  s_waitcnt lgkmcnt(12)
  v_mfma_f32_16x16x32_bf16 v[36:39], v[208:211], v[196:199], v[36:39]
  v_mfma_f32_16x16x32_bf16 v[44:47], v[208:211], v[200:203], v[44:47]
  s_waitcnt lgkmcnt(0)
  s_barrier
  v_mfma_f32_16x16x32_bf16 v[32:35], v[220:223], v[212:215], v[32:35]
  ds_read_b128 v[180:183], v50 offset:24576
  ds_read_b64_tr_b16 v[188:189], v56 offset:32768
  ds_read_b64_tr_b16 v[190:191], v56 offset:33280
  v_mfma_f32_16x16x32_bf16 v[40:43], v[220:223], v[216:219], v[40:43]
  ds_read_b128 v[184:187], v252 offset:24576
  ds_read_b64_tr_b16 v[192:193], v57 offset:32768
  ds_read_b64_tr_b16 v[194:195], v57 offset:33280
  v_mfma_f32_16x16x32_bf16 v[36:39], v[224:227], v[212:215], v[36:39]
  ds_read_b128 v[196:199], v51 offset:24576
  ds_read_b64_tr_b16 v[204:205], v56 offset:36864
  ds_read_b64_tr_b16 v[206:207], v56 offset:37376
  v_mfma_f32_16x16x32_bf16 v[44:47], v[224:227], v[216:219], v[44:47]
  ds_read_b128 v[200:203], v253 offset:24576
  ds_read_b64_tr_b16 v[208:209], v57 offset:36864
  ds_read_b64_tr_b16 v[210:211], v57 offset:37376
  v_mfma_f32_16x16x32_bf16 v[32:35], v[236:239], v[228:231], v[32:35]
  v_mfma_f32_16x16x32_bf16 v[40:43], v[236:239], v[232:235], v[40:43]
  v_mfma_f32_16x16x32_bf16 v[36:39], v[240:243], v[228:231], v[36:39]
  v_mfma_f32_16x16x32_bf16 v[44:47], v[240:243], v[232:235], v[44:47]
  s_waitcnt lgkmcnt(9)
  v_mfma_f32_16x16x32_bf16 v[32:35], v[188:191], v[180:183], v[32:35]
  ds_read_b128 v[212:215], v48 offset:8192
  ds_read_b64_tr_b16 v[220:221], v56 offset:40960
  ds_read_b64_tr_b16 v[222:223], v56 offset:41472
  s_waitcnt lgkmcnt(11)
  v_mfma_f32_16x16x32_bf16 v[40:43], v[188:191], v[184:187], v[40:43]
  ds_read_b128 v[216:219], v142 offset:8192
  ds_read_b64_tr_b16 v[224:225], v57 offset:40960
  ds_read_b64_tr_b16 v[226:227], v57 offset:41472
  s_waitcnt lgkmcnt(12)
  v_mfma_f32_16x16x32_bf16 v[36:39], v[192:195], v[180:183], v[36:39]
  ds_read_b128 v[228:231], v49 offset:8192
  ds_read_b64_tr_b16 v[236:237], v56 offset:45056
  ds_read_b64_tr_b16 v[238:239], v56 offset:45568
  v_mfma_f32_16x16x32_bf16 v[44:47], v[192:195], v[184:187], v[44:47]
  ds_read_b128 v[232:235], v143 offset:8192
  ds_read_b64_tr_b16 v[240:241], v57 offset:45056
  ds_read_b64_tr_b16 v[242:243], v57 offset:45568
  s_waitcnt lgkmcnt(15)
  v_mfma_f32_16x16x32_bf16 v[32:35], v[204:207], v[196:199], v[32:35]
  s_waitcnt lgkmcnt(14)
  v_mfma_f32_16x16x32_bf16 v[40:43], v[204:207], v[200:203], v[40:43]
  s_waitcnt lgkmcnt(12)
  v_mfma_f32_16x16x32_bf16 v[36:39], v[208:211], v[196:199], v[36:39]
  v_mfma_f32_16x16x32_bf16 v[44:47], v[208:211], v[200:203], v[44:47]
  s_waitcnt lgkmcnt(0)
  s_barrier
  v_mfma_f32_16x16x32_bf16 v[32:35], v[220:223], v[212:215], v[32:35]
  ds_read_b128 v[180:183], v52 offset:0
  ds_read_b64_tr_b16 v[188:189], v56 offset:49152
  ds_read_b64_tr_b16 v[190:191], v56 offset:49664
  v_mfma_f32_16x16x32_bf16 v[40:43], v[220:223], v[216:219], v[40:43]
  ds_read_b128 v[184:187], v254 offset:0
  ds_read_b64_tr_b16 v[192:193], v57 offset:49152
  ds_read_b64_tr_b16 v[194:195], v57 offset:49664
  v_mfma_f32_16x16x32_bf16 v[36:39], v[224:227], v[212:215], v[36:39]
  ds_read_b128 v[196:199], v53 offset:0
  ds_read_b64_tr_b16 v[204:205], v56 offset:53248
  ds_read_b64_tr_b16 v[206:207], v56 offset:53760
  v_mfma_f32_16x16x32_bf16 v[44:47], v[224:227], v[216:219], v[44:47]
  ds_read_b128 v[200:203], v255 offset:0
  ds_read_b64_tr_b16 v[208:209], v57 offset:53248
  ds_read_b64_tr_b16 v[210:211], v57 offset:53760
  v_mfma_f32_16x16x32_bf16 v[32:35], v[236:239], v[228:231], v[32:35]
  v_mfma_f32_16x16x32_bf16 v[40:43], v[236:239], v[232:235], v[40:43]
  v_mfma_f32_16x16x32_bf16 v[36:39], v[240:243], v[228:231], v[36:39]
  v_mfma_f32_16x16x32_bf16 v[44:47], v[240:243], v[232:235], v[44:47]
  s_waitcnt lgkmcnt(9)
  v_mfma_f32_16x16x32_bf16 v[32:35], v[188:191], v[180:183], v[32:35]
  ds_read_b128 v[212:215], v48 offset:16384
  ds_read_b64_tr_b16 v[220:221], v56 offset:57344
  ds_read_b64_tr_b16 v[222:223], v56 offset:57856
  s_waitcnt lgkmcnt(11)
  v_mfma_f32_16x16x32_bf16 v[40:43], v[188:191], v[184:187], v[40:43]
  ds_read_b128 v[216:219], v142 offset:16384
  ds_read_b64_tr_b16 v[224:225], v57 offset:57344
  ds_read_b64_tr_b16 v[226:227], v57 offset:57856
  s_waitcnt lgkmcnt(12)
  v_mfma_f32_16x16x32_bf16 v[36:39], v[192:195], v[180:183], v[36:39]
  v_mfma_f32_16x16x32_bf16 v[44:47], v[192:195], v[184:187], v[44:47]
  s_waitcnt lgkmcnt(9)
  v_mfma_f32_16x16x32_bf16 v[32:35], v[204:207], v[196:199], v[32:35]
  s_waitcnt lgkmcnt(8)
  v_mfma_f32_16x16x32_bf16 v[40:43], v[204:207], v[200:203], v[40:43]
  s_waitcnt lgkmcnt(6)
  v_mfma_f32_16x16x32_bf16 v[36:39], v[208:211], v[196:199], v[36:39]
  v_mfma_f32_16x16x32_bf16 v[44:47], v[208:211], v[200:203], v[44:47]
  s_waitcnt lgkmcnt(3)
  v_mfma_f32_16x16x32_bf16 v[32:35], v[220:223], v[212:215], v[32:35]
  s_waitcnt lgkmcnt(2)
  v_mfma_f32_16x16x32_bf16 v[40:43], v[220:223], v[216:219], v[40:43]
  s_waitcnt lgkmcnt(0)
  v_mfma_f32_16x16x32_bf16 v[36:39], v[224:227], v[212:215], v[36:39]
  v_mfma_f32_16x16x32_bf16 v[44:47], v[224:227], v[216:219], v[44:47]
  s_nop 2
  v_cvt_pk_bf16_f32 v148, v32, v33
  v_cvt_pk_bf16_f32 v149, v34, v35
  s_nop 1
  v_cvt_pk_bf16_f32 v150, v36, v37
  v_cvt_pk_bf16_f32 v151, v38, v39
  s_nop 0
  v_permlane16_swap_b32 v148, v150
  v_permlane16_swap_b32 v149, v151
  buffer_store_dwordx4 v[148:151], v61, s[32:35], 0 offen
  v_cvt_pk_bf16_f32 v152, v40, v41
  v_cvt_pk_bf16_f32 v153, v42, v43
  v_cvt_pk_bf16_f32 v154, v44, v45
  v_cvt_pk_bf16_f32 v155, v46, v47
  s_nop 0
  v_permlane16_swap_b32 v152, v154
  v_permlane16_swap_b32 v153, v155
  buffer_store_dwordx4 v[152:155], v141, s[32:35], 0 offen
  s_or_b32 s74, s50, s48
  s_cmp_eq_u32 s74, 0
  s_cbranch_scc0 LC_ep_24
  v_lshlrev_b32 v12, 9, v1
  v_add_u32 v13, 14680064, v12
  s_add_u32 s74, s49, 1
  s_mov_b32 s75, 0
LC_el_25:
  buffer_load_dword v4, v13, s[36:39], 0 offen offset:0 sc1
  buffer_load_dword v5, v13, s[36:39], 0 offen offset:128 sc1
  buffer_load_dword v6, v13, s[36:39], 0 offen offset:256 sc1
  buffer_load_dword v7, v13, s[36:39], 0 offen offset:384 sc1
  s_waitcnt vmcnt(0)
  v_subrev_u32 v4, s74, v4
  v_subrev_u32 v5, s74, v5
  v_subrev_u32 v6, s74, v6
  v_subrev_u32 v7, s74, v7
  v_max_u32 v4, v4, v5
  v_max_u32 v6, v6, v7
  v_max_u32 v4, v4, v6
  v_cmp_ge_u32 vcc, 6, v4
  s_add_u32 s75, s75, 1
  s_nop 2
  s_cmp_eq_u64 vcc, exec
  s_cbranch_scc1 LC_ed_26
  s_cmp_lt_u32 s75, 400000
  s_cbranch_scc1 LC_el_25
LC_ed_26:
  v_mov_b32 v4, s49
  v_mov_b32 v5, 14745600
  s_mov_b64 exec, 1
  buffer_store_dword v4, v5, s[36:39], 0 offen sc1
LC_ep_24:
  s_waitcnt vmcnt(0)
L_END:
  s_endpgm
L_LOADER:
  s_sub_u32 s79, s48, 4
  v_lshrrev_b32 v4, 3, v1
  v_and_b32 v6, 7, v1
  s_lshl_b32 s92, s79, 11
  s_lshl_b32 s76, s46, 6
  s_lshl_b32 s77, s79, 4
  s_add_u32 s76, s76, s77
  s_lshl_b32 s75, s47, 7
  v_add_u32 v5, 0, v3
  v_xor_b32 v5, v5, v6
  v_lshlrev_b32 v7, 4, v5
  v_add_u32 v9, 0, v4
  v_add_u32 v9, s76, v9
  v_lshl_add_u32 v16, v9, 10, v7
  v_and_b32 v5, 1, v3
  v_lshrrev_b32 v11, 1, v6
  v_xor_b32 v5, v5, v11
  v_lshlrev_b32 v5, 5, v5
  v_and_b32 v11, 1, v1
  v_lshl_add_u32 v5, v11, 4, v5
  v_add_u32 v5, s75, v5
  v_add_u32 v11, 0, v4
  v_add_u32 v11, s77, v11
  v_lshl_add_u32 v18, v11, 10, v5
  v_mul_u32_u24 v20, 3072, v11
  v_xor_b32 v13, 512, v5
  v_add_u32 v20, v20, v13
  v_add_u32 v5, 4, v3
  v_xor_b32 v5, v5, v6
  v_lshlrev_b32 v8, 4, v5
  v_add_u32 v10, 8, v4
  v_add_u32 v10, s76, v10
  v_lshl_add_u32 v17, v10, 10, v8
  v_and_b32 v5, 1, v3
  v_or_b32 v5, 2, v5
  v_lshrrev_b32 v11, 1, v6
  v_xor_b32 v5, v5, v11
  v_lshlrev_b32 v5, 5, v5
  v_and_b32 v11, 1, v1
  v_lshl_add_u32 v5, v11, 4, v5
  v_add_u32 v5, s75, v5
  v_add_u32 v11, 8, v4
  v_add_u32 v11, s77, v11
  v_lshl_add_u32 v19, v11, 10, v5
  v_mul_u32_u24 v21, 3072, v11
  v_xor_b32 v13, 512, v5
  v_add_u32 v21, v21, v13
  v_mov_b32 v12, 14745600
  s_waitcnt lgkmcnt(0)
  s_mov_b32 s4, s52
  s_and_b32 s5, s53, 65535
  s_mov_b32 s6, 2097152
  s_mov_b32 s7, 131072
  s_mov_b32 s12, s60
  s_and_b32 s13, s61, 65535
  s_mov_b32 s14, 524288
  s_mov_b32 s15, 131072
  s_cmp_eq_u32 s79, 0
  s_cbranch_scc0 LL_tlb_1
  s_load_dword s98, s[54:55], 0
  s_load_dword s98, s[66:67], 0
  s_mov_b32 s99, 4194304
  s_load_dword s98, s[72:73], s99
  s_mov_b32 s99, 12582912
  s_load_dword s98, s[72:73], s99
LL_tlb_1:
  s_cmp_eq_u32 s79, 1
  s_cbranch_scc0 LL_tlb_2
  s_load_dword s98, s[62:63], 0
  s_load_dword s98, s[68:69], 0
  s_mov_b32 s99, 6291456
  s_load_dword s98, s[72:73], s99
  s_mov_b32 s99, 14680064
  s_load_dword s98, s[72:73], s99
LL_tlb_2:
  s_cmp_eq_u32 s79, 2
  s_cbranch_scc0 LL_tlb_3
  s_load_dword s98, s[64:65], 0
  s_load_dword s98, s[72:73], 0
  s_mov_b32 s99, 8388608
  s_load_dword s98, s[72:73], s99
LL_tlb_3:
  s_cmp_eq_u32 s79, 3
  s_cbranch_scc0 LL_tlb_4
  s_load_dword s98, s[56:57], 0
  s_mov_b32 s99, 2097152
  s_load_dword s98, s[72:73], s99
  s_mov_b32 s99, 10485760
  s_load_dword s98, s[72:73], s99
LL_tlb_4:
  s_add_u32 s3, s51, 0
  s_and_b32 s3, s3, 7
  s_lshl_b32 s78, s3, 7
  s_lshl_b32 s3, s3, 16
  s_add_u32 m0, s92, 0
  s_add_u32 s86, s78, 0
  buffer_load_dwordx4 v16, s[4:7], s86 offen lds
  s_add_u32 m0, s92, 1024
  s_add_u32 s86, s78, 0
  buffer_load_dwordx4 v17, s[4:7], s86 offen lds
  s_add_u32 m0, s92, 65536
  s_add_u32 s86, s3, 0
  buffer_load_dwordx4 v18, s[12:15], s86 offen lds
  s_add_u32 m0, s92, 66560
  s_add_u32 s86, s3, 0
  buffer_load_dwordx4 v19, s[12:15], s86 offen lds
  s_mov_b32 s36, s72
  s_and_b32 s37, s73, 65535
  s_mov_b32 s38, 16777216
  s_mov_b32 s39, 131072
  buffer_load_dword v46, v12, s[36:39], 0 offen sc1
  s_add_u32 s3, s51, 1
  s_and_b32 s3, s3, 7
  s_lshl_b32 s78, s3, 7
  s_lshl_b32 s3, s3, 16
  s_add_u32 m0, s92, 8192
  s_add_u32 s86, s78, 0
  buffer_load_dwordx4 v16, s[4:7], s86 offen lds
  s_add_u32 m0, s92, 9216
  s_add_u32 s86, s78, 0
  buffer_load_dwordx4 v17, s[4:7], s86 offen lds
  s_add_u32 m0, s92, 73728
  s_add_u32 s86, s3, 0
  buffer_load_dwordx4 v18, s[12:15], s86 offen lds
  s_add_u32 m0, s92, 74752
  s_add_u32 s86, s3, 0
  buffer_load_dwordx4 v19, s[12:15], s86 offen lds
  s_mov_b32 s8, s54
  s_and_b32 s9, s55, 65535
  s_mov_b32 s10, 1572864
  s_mov_b32 s11, 131072
  s_mov_b32 s40, s72
  s_and_b32 s41, s73, 65535
  s_mov_b32 s42, 2359296
  s_mov_b32 s43, 131072
  s_add_u32 s3, s51, 2
  s_and_b32 s3, s3, 7
  s_lshl_b32 s78, s3, 7
  s_lshl_b32 s3, s3, 16
  s_add_u32 m0, s92, 16384
  s_add_u32 s86, s78, 0
  buffer_load_dwordx4 v16, s[4:7], s86 offen lds
  s_add_u32 m0, s92, 17408
  s_add_u32 s86, s78, 0
  buffer_load_dwordx4 v17, s[4:7], s86 offen lds
  s_add_u32 m0, s92, 81920
  s_add_u32 s86, s3, 0
  buffer_load_dwordx4 v18, s[12:15], s86 offen lds
  s_add_u32 m0, s92, 82944
  s_add_u32 s86, s3, 0
  buffer_load_dwordx4 v19, s[12:15], s86 offen lds
  s_mov_b32 s20, s56
  s_and_b32 s21, s57, 65535
  s_mov_b32 s22, 524288
  s_mov_b32 s23, 131072
  s_mov_b32 s16, s62
  s_and_b32 s17, s63, 65535
  s_mov_b32 s18, 524288
  s_mov_b32 s19, 131072
  s_mov_b32 s24, s64
  s_and_b32 s25, s65, 65535
  s_mov_b32 s26, 1409024
  s_mov_b32 s27, 131072
  s_mov_b32 s28, s66
  s_and_b32 s29, s67, 65535
  s_mov_b32 s30, 1409024
  s_mov_b32 s31, 131072
  s_waitcnt vmcnt(11)
  s_waitcnt vmcnt(9)
  s_barrier
  s_add_u32 s3, s51, 3
  s_and_b32 s3, s3, 7
  s_lshl_b32 s78, s3, 7
  s_lshl_b32 s3, s3, 16
  s_add_u32 m0, s92, 24576
  s_add_u32 s86, s78, 0
  buffer_load_dwordx4 v16, s[4:7], s86 offen lds
  s_add_u32 m0, s92, 25600
  s_add_u32 s86, s78, 0
  buffer_load_dwordx4 v17, s[4:7], s86 offen lds
  s_add_u32 m0, s92, 90112
  s_add_u32 s86, s3, 0
  buffer_load_dwordx4 v18, s[12:15], s86 offen lds
  s_add_u32 m0, s92, 91136
  s_add_u32 s86, s3, 0
  buffer_load_dwordx4 v19, s[12:15], s86 offen lds
  s_add_u32 s3, s51, 4
  s_and_b32 s3, s3, 7
  s_lshl_b32 s78, s3, 7
  s_lshl_b32 s3, s3, 16
  s_add_u32 m0, s92, 32768
  s_add_u32 s86, s78, 0
  buffer_load_dwordx4 v16, s[4:7], s86 offen lds
  s_add_u32 m0, s92, 33792
  s_add_u32 s86, s78, 0
  buffer_load_dwordx4 v17, s[4:7], s86 offen lds
  s_add_u32 m0, s92, 98304
  s_add_u32 s86, s3, 0
  buffer_load_dwordx4 v18, s[12:15], s86 offen lds
  s_add_u32 m0, s92, 99328
  s_add_u32 s86, s3, 0
  buffer_load_dwordx4 v19, s[12:15], s86 offen lds
  s_waitcnt vmcnt(14)
  s_waitcnt vmcnt(12)
  s_barrier
  s_add_u32 s3, s51, 5
  s_and_b32 s3, s3, 7
  s_lshl_b32 s78, s3, 7
  s_lshl_b32 s3, s3, 16
  s_add_u32 m0, s92, 40960
  s_add_u32 s86, s78, 0
  buffer_load_dwordx4 v16, s[4:7], s86 offen lds
  s_add_u32 m0, s92, 41984
  s_add_u32 s86, s78, 0
  buffer_load_dwordx4 v17, s[4:7], s86 offen lds
  s_add_u32 m0, s92, 106496
  s_add_u32 s86, s3, 0
  buffer_load_dwordx4 v18, s[12:15], s86 offen lds
  s_add_u32 m0, s92, 107520
  s_add_u32 s86, s3, 0
  buffer_load_dwordx4 v19, s[12:15], s86 offen lds
  s_add_u32 s3, s51, 6
  s_and_b32 s3, s3, 7
  s_lshl_b32 s78, s3, 7
  s_lshl_b32 s3, s3, 16
  s_add_u32 m0, s92, 49152
  s_add_u32 s86, s78, 0
  buffer_load_dwordx4 v16, s[4:7], s86 offen lds
  s_add_u32 m0, s92, 50176
  s_add_u32 s86, s78, 0
  buffer_load_dwordx4 v17, s[4:7], s86 offen lds
  s_add_u32 m0, s92, 114688
  s_add_u32 s86, s3, 0
  buffer_load_dwordx4 v18, s[12:15], s86 offen lds
  s_add_u32 m0, s92, 115712
  s_add_u32 s86, s3, 0
  buffer_load_dwordx4 v19, s[12:15], s86 offen lds
  s_waitcnt vmcnt(14)
  s_waitcnt vmcnt(12)
  s_barrier
  s_add_u32 s3, s51, 7
  s_and_b32 s3, s3, 7
  s_lshl_b32 s78, s3, 7
  s_lshl_b32 s3, s3, 16
  s_add_u32 m0, s92, 57344
  s_add_u32 s86, s78, 0
  buffer_load_dwordx4 v16, s[4:7], s86 offen lds
  s_add_u32 m0, s92, 58368
  s_add_u32 s86, s78, 0
  buffer_load_dwordx4 v17, s[4:7], s86 offen lds
  s_add_u32 m0, s92, 122880
  s_add_u32 s86, s3, 0
  buffer_load_dwordx4 v18, s[12:15], s86 offen lds
  s_add_u32 m0, s92, 123904
  s_add_u32 s86, s3, 0
  buffer_load_dwordx4 v19, s[12:15], s86 offen lds
  s_waitcnt vmcnt(10)
  s_waitcnt vmcnt(8)
  s_barrier
  s_add_u32 s3, s51, 0
  s_and_b32 s3, s3, 7
  s_mul_i32 s3, s3, 196608
  s_add_u32 m0, s92, 131072
  s_add_u32 s86, s3, 0
  buffer_load_dwordx4 v20, s[8:11], s86 offen lds
  s_add_u32 m0, s92, 132096
  s_add_u32 s86, s3, 0
  buffer_load_dwordx4 v21, s[8:11], s86 offen lds
  s_add_u32 s3, s51, 0
  s_and_b32 s3, s3, 7
  s_mul_i32 s3, s3, 196608
  s_add_u32 m0, s92, 139264
  s_add_u32 s86, s3, 1024
  buffer_load_dwordx4 v20, s[8:11], s86 offen lds
  s_add_u32 m0, s92, 140288
  s_add_u32 s86, s3, 1024
  buffer_load_dwordx4 v21, s[8:11], s86 offen lds
  s_add_u32 s3, s51, 0
  s_and_b32 s3, s3, 7
  s_mul_i32 s3, s3, 196608
  s_add_u32 m0, s92, 147456
  s_add_u32 s86, s3, 2048
  buffer_load_dwordx4 v20, s[8:11], s86 offen lds
  s_add_u32 m0, s92, 148480
  s_add_u32 s86, s3, 2048
  buffer_load_dwordx4 v21, s[8:11], s86 offen lds
  s_waitcnt vmcnt(8)
  s_waitcnt vmcnt(6)
  s_barrier
  s_add_u32 s3, s51, 1
  s_and_b32 s3, s3, 7
  s_mul_i32 s3, s3, 196608
  s_add_u32 m0, s92, 65536
  s_add_u32 s86, s3, 0
  buffer_load_dwordx4 v20, s[8:11], s86 offen lds
  s_add_u32 m0, s92, 66560
  s_add_u32 s86, s3, 0
  buffer_load_dwordx4 v21, s[8:11], s86 offen lds
  s_add_u32 s3, s51, 1
  s_and_b32 s3, s3, 7
  s_mul_i32 s3, s3, 196608
  s_add_u32 m0, s92, 73728
  s_add_u32 s86, s3, 1024
  buffer_load_dwordx4 v20, s[8:11], s86 offen lds
  s_add_u32 m0, s92, 74752
  s_add_u32 s86, s3, 1024
  buffer_load_dwordx4 v21, s[8:11], s86 offen lds
  s_add_u32 s3, s51, 1
  s_and_b32 s3, s3, 7
  s_mul_i32 s3, s3, 196608
  s_add_u32 m0, s92, 81920
  s_add_u32 s86, s3, 2048
  buffer_load_dwordx4 v20, s[8:11], s86 offen lds
  s_add_u32 m0, s92, 82944
  s_add_u32 s86, s3, 2048
  buffer_load_dwordx4 v21, s[8:11], s86 offen lds
  s_lshr_b32 s90, s46, 1
  s_lshr_b32 s74, s47, 2
  s_lshl_b32 s74, s74, 3
  s_and_b32 s75, s46, 1
  s_lshl_b32 s75, s75, 2
  s_or_b32 s74, s74, s75
  s_and_b32 s75, s47, 3
  s_or_b32 s91, s74, s75
  s_mov_b32 s62, 4718592
  s_mov_b32 s63, 2359296
  s_mov_b32 s64, 7077888
  s_lshl_b32 s67, s50, 7
  s_lshl_b32 s74, s48, 2
  s_add_u32 s67, s67, s74
  s_add_u32 s67, s67, 14680064
  s_mul_i32 s93, s79, 3072
  s_lshl_b32 s94, s79, 12
  s_and_b32 s74, s46, 7
  s_mul_i32 s74, s74, 3
  s_and_b32 s75, s47, 3
  s_mul_i32 s75, s75, 5
  s_add_u32 s74, s74, s75
  s_cmp_ge_u32 s74, 22
  s_cselect_b32 s75, 22, 0
  s_sub_u32 s95, s74, s75
  s_mov_b32 s95, 0
  v_mul_u32_u24 v38, 2816, v9
  v_add_u32 v38, v38, v7
  v_mul_u32_u24 v39, 2816, v10
  v_add_u32 v39, v39, v8
  s_mul_i32 s75, s91, 192
  s_lshl_b32 s74, s90, 7
  s_lshl_b32 s76, s79, 5
  s_add_u32 s78, s74, s76
  s_and_b32 s76, s79, 1
  s_lshl_b32 s76, s76, 6
  s_lshr_b32 s77, s79, 1
  s_lshl_b32 s77, s77, 4
  s_add_u32 s66, s76, s77
  s_mul_i32 s65, s66, 208
  s_add_u32 s76, s74, s66
  s_mov_b32 s74, s78
  s_mul_i32 s76, s76, 2816
  s_add_u32 s76, s76, s75
  s_add_u32 s76, s76, 7077888
  s_cmp_eq_u32 s91, 14
  s_cselect_b32 s66, 8, 12
  v_add_u32 v13, 0, v1
  v_mul_u32_u24 v14, 171, v13
  v_lshrrev_b32 v15, 11, v14
  v_mul_u32_u24 v14, 12, v15
  v_sub_u32 v13, v13, v14
  v_lshrrev_b32 v14, 1, v13
  v_lshrrev_b32 v5, 3, v15
  v_xor_b32 v14, v14, v5
  v_lshlrev_b32 v14, 5, v14
  v_and_b32 v5, 1, v13
  v_lshl_add_u32 v14, v5, 4, v14
  v_mul_u32_u24 v5, 2752, v15
  v_add3_u32 v30, v14, v5, s75
  v_mul_u32_u24 v14, 208, v15
  v_lshl_add_u32 v14, v13, 4, v14
  v_add_u32 v44, s65, v14
  v_mul_u32_u24 v14, 2816, v15
  v_lshl_add_u32 v14, v13, 4, v14
  v_add_u32 v14, s76, v14
  v_cmp_gt_u32 vcc, s66, v13
  v_mov_b32 v5, 2130706432
  s_nop 0
  v_cndmask_b32 v33, v5, v14, vcc
  v_add_u32 v13, 64, v1
  v_mul_u32_u24 v14, 171, v13
  v_lshrrev_b32 v15, 11, v14
  v_mul_u32_u24 v14, 12, v15
  v_sub_u32 v13, v13, v14
  v_lshrrev_b32 v14, 1, v13
  v_lshrrev_b32 v5, 3, v15
  v_xor_b32 v14, v14, v5
  v_lshlrev_b32 v14, 5, v14
  v_and_b32 v5, 1, v13
  v_lshl_add_u32 v14, v5, 4, v14
  v_mul_u32_u24 v5, 2752, v15
  v_add3_u32 v31, v14, v5, s75
  v_mul_u32_u24 v14, 208, v15
  v_lshl_add_u32 v14, v13, 4, v14
  v_add_u32 v49, s65, v14
  v_mul_u32_u24 v14, 2816, v15
  v_lshl_add_u32 v14, v13, 4, v14
  v_add_u32 v14, s76, v14
  v_cmp_gt_u32 vcc, s66, v13
  v_mov_b32 v5, 2130706432
  s_nop 0
  v_cndmask_b32 v34, v5, v14, vcc
  v_add_u32 v13, 128, v1
  v_mul_u32_u24 v14, 171, v13
  v_lshrrev_b32 v15, 11, v14
  v_mul_u32_u24 v14, 12, v15
  v_sub_u32 v13, v13, v14
  v_lshrrev_b32 v14, 1, v13
  v_lshrrev_b32 v5, 3, v15
  v_xor_b32 v14, v14, v5
  v_lshlrev_b32 v14, 5, v14
  v_and_b32 v5, 1, v13
  v_lshl_add_u32 v14, v5, 4, v14
  v_mul_u32_u24 v5, 2752, v15
  v_add3_u32 v32, v14, v5, s75
  v_mul_u32_u24 v14, 208, v15
  v_lshl_add_u32 v14, v13, 4, v14
  v_add_u32 v50, s65, v14
  v_mul_u32_u24 v14, 2816, v15
  v_lshl_add_u32 v14, v13, 4, v14
  v_add_u32 v14, s76, v14
  v_cmp_gt_u32 vcc, s66, v13
  v_mov_b32 v5, 2130706432
  s_nop 0
  v_cndmask_b32 v35, v5, v14, vcc
  v_add_u32 v5, s74, v4
  v_add_u32 v11, 0, v5
  v_mul_u32_u24 v11, 1152, v11
  v_add_u32 v36, v11, v7
  v_add_u32 v11, 8, v5
  v_mul_u32_u24 v11, 1152, v11
  v_add_u32 v37, v11, v8
  v_xor_b32 v5, v6, v4
  v_lshlrev_b32 v5, 4, v5
  s_lshl_b32 s74, s79, 4
  v_add_u32 v11, 0, v4
  v_add_u32 v11, s74, v11
  v_lshl_add_u32 v40, v11, 7, v5
  v_add_u32 v40, 131072, v40
  v_mul_u32_u24 v13, 1152, v9
  v_add_u32 v53, v13, v7
  v_lshl_add_u32 v13, v6, 4, v13
  s_xor_b32 s75, s47, 4
  s_lshl_b32 s75, s75, 7
  v_add_u32 v42, s75, v13
  v_add_u32 v11, 8, v4
  v_add_u32 v11, s74, v11
  v_lshl_add_u32 v41, v11, 7, v5
  v_add_u32 v41, 131072, v41
  v_mul_u32_u24 v13, 1152, v10
  v_add_u32 v54, v13, v8
  v_lshl_add_u32 v13, v6, 4, v13
  s_xor_b32 s75, s47, 4
  s_lshl_b32 s75, s75, 7
  v_add_u32 v43, s75, v13
  s_lshl_b32 s78, s46, 3
  v_add_u32 v13, s78, v1
  v_cmp_gt_u32 vcc, 256, v13
  v_cmp_gt_u32 s[72:73], 8, v1
  s_nop 3
  s_and_b64 vcc, vcc, s[72:73]
  v_mov_b32 v14, s50
  v_cndmask_b32 v13, v14, v13, vcc
  v_lshlrev_b32 v13, 7, v13
  v_add_u32 v45, 14680080, v13
  s_lshl_b32 s74, s90, 1
  s_lshr_b32 s75, s79, 1
  s_add_u32 s74, s74, s75
  s_lshl_b32 s74, s74, 13
  s_and_b32 s75, s79, 1
  s_lshl_b32 s75, s75, 8
  s_add_u32 s74, s74, s75
  s_add_u32 s74, s74, 12845056
  v_and_b32 v13, 31, v1
  v_lshrrev_b32 v14, 5, v1
  v_lshlrev_b32 v14, 12, v14
  v_lshl_add_u32 v14, v13, 3, v14
  v_add_u32 v51, s74, v14
  s_lshl_b32 s74, s79, 7
  s_add_u32 s74, s74, 98304
  v_lshlrev_b32 v13, 2, v13
  v_add_u32 v52, s74, v13
  s_barrier
  s_add_u32 s3, s51, 2
  s_and_b32 s3, s3, 7
  s_mul_i32 s3, s3, 196608
  s_add_u32 m0, s92, 90112
  s_add_u32 s86, s3, 0
  buffer_load_dwordx4 v20, s[8:11], s86 offen lds
  s_add_u32 m0, s92, 91136
  s_add_u32 s86, s3, 0
  buffer_load_dwordx4 v21, s[8:11], s86 offen lds
  s_add_u32 s3, s51, 2
  s_and_b32 s3, s3, 7
  s_mul_i32 s3, s3, 196608
  s_add_u32 m0, s92, 98304
  s_add_u32 s86, s3, 1024
  buffer_load_dwordx4 v20, s[8:11], s86 offen lds
  s_add_u32 m0, s92, 99328
  s_add_u32 s86, s3, 1024
  buffer_load_dwordx4 v21, s[8:11], s86 offen lds
  s_add_u32 s3, s51, 2
  s_and_b32 s3, s3, 7
  s_mul_i32 s3, s3, 196608
  s_add_u32 m0, s92, 106496
  s_add_u32 s86, s3, 2048
  buffer_load_dwordx4 v20, s[8:11], s86 offen lds
  s_add_u32 m0, s92, 107520
  s_add_u32 s86, s3, 2048
  buffer_load_dwordx4 v21, s[8:11], s86 offen lds
  v_readfirstlane_b32 s49, v46
  s_nop 3
  s_add_u32 s49, s49, 8
  s_waitcnt vmcnt(12)
  s_barrier
  s_waitcnt vmcnt(6)
  s_barrier
  s_add_u32 s3, s51, 3
  s_and_b32 s3, s3, 7
  s_mul_i32 s3, s3, 196608
  s_add_u32 m0, s92, 131072
  s_add_u32 s86, s3, 0
  buffer_load_dwordx4 v20, s[8:11], s86 offen lds
  s_add_u32 m0, s92, 132096
  s_add_u32 s86, s3, 0
  buffer_load_dwordx4 v21, s[8:11], s86 offen lds
  s_add_u32 s3, s51, 3
  s_and_b32 s3, s3, 7
  s_mul_i32 s3, s3, 196608
  s_add_u32 m0, s92, 139264
  s_add_u32 s86, s3, 1024
  buffer_load_dwordx4 v20, s[8:11], s86 offen lds
  s_add_u32 m0, s92, 140288
  s_add_u32 s86, s3, 1024
  buffer_load_dwordx4 v21, s[8:11], s86 offen lds
  s_add_u32 s3, s51, 3
  s_and_b32 s3, s3, 7
  s_mul_i32 s3, s3, 196608
  s_add_u32 m0, s92, 147456
  s_add_u32 s86, s3, 2048
  buffer_load_dwordx4 v20, s[8:11], s86 offen lds
  s_add_u32 m0, s92, 148480
  s_add_u32 s86, s3, 2048
  buffer_load_dwordx4 v21, s[8:11], s86 offen lds
  s_mov_b32 s3, 0
  s_lshl_b32 s3, s3, 16
  s_add_u32 m0, s92, 0
  s_add_u32 s86, s3, 0
  buffer_load_dwordx4 v18, s[16:19], s86 offen lds
  s_add_u32 m0, s92, 1024
  s_add_u32 s86, s3, 0
  buffer_load_dwordx4 v19, s[16:19], s86 offen lds
  s_waitcnt vmcnt(8)
  s_barrier
  s_add_u32 s3, s51, 4
  s_and_b32 s3, s3, 7
  s_mul_i32 s3, s3, 196608
  s_add_u32 m0, s92, 65536
  s_add_u32 s86, s3, 0
  buffer_load_dwordx4 v20, s[8:11], s86 offen lds
  s_add_u32 m0, s92, 66560
  s_add_u32 s86, s3, 0
  buffer_load_dwordx4 v21, s[8:11], s86 offen lds
  s_add_u32 s3, s51, 4
  s_and_b32 s3, s3, 7
  s_mul_i32 s3, s3, 196608
  s_add_u32 m0, s92, 73728
  s_add_u32 s86, s3, 1024
  buffer_load_dwordx4 v20, s[8:11], s86 offen lds
  s_add_u32 m0, s92, 74752
  s_add_u32 s86, s3, 1024
  buffer_load_dwordx4 v21, s[8:11], s86 offen lds
  s_add_u32 s3, s51, 4
  s_and_b32 s3, s3, 7
  s_mul_i32 s3, s3, 196608
  s_add_u32 m0, s92, 81920
  s_add_u32 s86, s3, 2048
  buffer_load_dwordx4 v20, s[8:11], s86 offen lds
  s_add_u32 m0, s92, 82944
  s_add_u32 s86, s3, 2048
  buffer_load_dwordx4 v21, s[8:11], s86 offen lds
  s_mov_b32 s3, 1
  s_lshl_b32 s3, s3, 16
  s_add_u32 m0, s92, 8192
  s_add_u32 s86, s3, 0
  buffer_load_dwordx4 v18, s[16:19], s86 offen lds
  s_add_u32 m0, s92, 9216
  s_add_u32 s86, s3, 0
  buffer_load_dwordx4 v19, s[16:19], s86 offen lds
  s_waitcnt vmcnt(10)
  s_barrier
  s_add_u32 s3, s51, 5
  s_and_b32 s3, s3, 7
  s_mul_i32 s3, s3, 196608
  s_add_u32 m0, s92, 90112
  s_add_u32 s86, s3, 0
  buffer_load_dwordx4 v20, s[8:11], s86 offen lds
  s_add_u32 m0, s92, 91136
  s_add_u32 s86, s3, 0
  buffer_load_dwordx4 v21, s[8:11], s86 offen lds
  s_add_u32 s3, s51, 5
  s_and_b32 s3, s3, 7
  s_mul_i32 s3, s3, 196608
  s_add_u32 m0, s92, 98304
  s_add_u32 s86, s3, 1024
  buffer_load_dwordx4 v20, s[8:11], s86 offen lds
  s_add_u32 m0, s92, 99328
  s_add_u32 s86, s3, 1024
  buffer_load_dwordx4 v21, s[8:11], s86 offen lds
  s_add_u32 s3, s51, 5
  s_and_b32 s3, s3, 7
  s_mul_i32 s3, s3, 196608
  s_add_u32 m0, s92, 106496
  s_add_u32 s86, s3, 2048
  buffer_load_dwordx4 v20, s[8:11], s86 offen lds
  s_add_u32 m0, s92, 107520
  s_add_u32 s86, s3, 2048
  buffer_load_dwordx4 v21, s[8:11], s86 offen lds
  s_mov_b32 s3, 2
  s_lshl_b32 s3, s3, 16
  s_add_u32 m0, s92, 16384
  s_add_u32 s86, s3, 0
  buffer_load_dwordx4 v18, s[16:19], s86 offen lds
  s_add_u32 m0, s92, 17408
  s_add_u32 s86, s3, 0
  buffer_load_dwordx4 v19, s[16:19], s86 offen lds
  s_waitcnt vmcnt(10)
  s_barrier
  s_add_u32 s3, s51, 6
  s_and_b32 s3, s3, 7
  s_mul_i32 s3, s3, 196608
  s_add_u32 m0, s92, 131072
  s_add_u32 s86, s3, 0
  buffer_load_dwordx4 v20, s[8:11], s86 offen lds
  s_add_u32 m0, s92, 132096
  s_add_u32 s86, s3, 0
  buffer_load_dwordx4 v21, s[8:11], s86 offen lds
  s_add_u32 s3, s51, 6
  s_and_b32 s3, s3, 7
  s_mul_i32 s3, s3, 196608
  s_add_u32 m0, s92, 139264
  s_add_u32 s86, s3, 1024
  buffer_load_dwordx4 v20, s[8:11], s86 offen lds
  s_add_u32 m0, s92, 140288
  s_add_u32 s86, s3, 1024
  buffer_load_dwordx4 v21, s[8:11], s86 offen lds
  s_add_u32 s3, s51, 6
  s_and_b32 s3, s3, 7
  s_mul_i32 s3, s3, 196608
  s_add_u32 m0, s92, 147456
  s_add_u32 s86, s3, 2048
  buffer_load_dwordx4 v20, s[8:11], s86 offen lds
  s_add_u32 m0, s92, 148480
  s_add_u32 s86, s3, 2048
  buffer_load_dwordx4 v21, s[8:11], s86 offen lds
  s_mov_b32 s3, 3
  s_lshl_b32 s3, s3, 16
  s_add_u32 m0, s92, 24576
  s_add_u32 s86, s3, 0
  buffer_load_dwordx4 v18, s[16:19], s86 offen lds
  s_add_u32 m0, s92, 25600
  s_add_u32 s86, s3, 0
  buffer_load_dwordx4 v19, s[16:19], s86 offen lds
  s_waitcnt vmcnt(10)
  s_barrier
  s_add_u32 s3, s51, 7
  s_and_b32 s3, s3, 7
  s_mul_i32 s3, s3, 196608
  s_add_u32 m0, s92, 65536
  s_add_u32 s86, s3, 0
  buffer_load_dwordx4 v20, s[8:11], s86 offen lds
  s_add_u32 m0, s92, 66560
  s_add_u32 s86, s3, 0
  buffer_load_dwordx4 v21, s[8:11], s86 offen lds
  s_add_u32 s3, s51, 7
  s_and_b32 s3, s3, 7
  s_mul_i32 s3, s3, 196608
  s_add_u32 m0, s92, 73728
  s_add_u32 s86, s3, 1024
  buffer_load_dwordx4 v20, s[8:11], s86 offen lds
  s_add_u32 m0, s92, 74752
  s_add_u32 s86, s3, 1024
  buffer_load_dwordx4 v21, s[8:11], s86 offen lds
  s_add_u32 s3, s51, 7
  s_and_b32 s3, s3, 7
  s_mul_i32 s3, s3, 196608
  s_add_u32 m0, s92, 81920
  s_add_u32 s86, s3, 2048
  buffer_load_dwordx4 v20, s[8:11], s86 offen lds
  s_add_u32 m0, s92, 82944
  s_add_u32 s86, s3, 2048
  buffer_load_dwordx4 v21, s[8:11], s86 offen lds
  s_mov_b32 s3, 4
  s_lshl_b32 s3, s3, 16
  s_add_u32 m0, s92, 32768
  s_add_u32 s86, s3, 0
  buffer_load_dwordx4 v18, s[16:19], s86 offen lds
  s_add_u32 m0, s92, 33792
  s_add_u32 s86, s3, 0
  buffer_load_dwordx4 v19, s[16:19], s86 offen lds
  s_waitcnt vmcnt(10)
  s_barrier
  s_mov_b32 s3, 5
  s_lshl_b32 s3, s3, 16
  s_add_u32 m0, s92, 40960
  s_add_u32 s86, s3, 0
  buffer_load_dwordx4 v18, s[16:19], s86 offen lds
  s_add_u32 m0, s92, 41984
  s_add_u32 s86, s3, 0
  buffer_load_dwordx4 v19, s[16:19], s86 offen lds
  s_waitcnt vmcnt(4)
  s_barrier
  s_mov_b32 s3, 6
  s_lshl_b32 s3, s3, 16
  s_add_u32 m0, s92, 49152
  s_add_u32 s86, s3, 0
  buffer_load_dwordx4 v18, s[16:19], s86 offen lds
  s_add_u32 m0, s92, 50176
  s_add_u32 s86, s3, 0
  buffer_load_dwordx4 v19, s[16:19], s86 offen lds
  s_waitcnt lgkmcnt(0)
  v_mov_b32 v11, 2130706432
  s_mov_b32 s74, 0
  s_lshr_b32 s74, s74, 1
  s_lshr_b32 s75, s74, 1
  s_add_u32 s75, s75, 1
  s_sub_u32 s76, 0, s75
  s_bitcmp1_b32 s74, 0
  s_cselect_b32 s75, s75, s76
  v_add_u32 v5, s75, v9
  v_mul_i32_i24 v12, 1152, v5
  v_add_u32 v96, v12, v7
  v_cmp_gt_i32 vcc, 0, v5
  s_nop 1
  v_cndmask_b32 v96, v96, v11, vcc
  v_add_u32 v5, s75, v10
  v_mul_i32_i24 v12, 1152, v5
  v_add_u32 v97, v12, v8
  v_cmp_gt_i32 vcc, 0, v5
  s_nop 1
  v_cndmask_b32 v97, v97, v11, vcc
  s_mov_b32 s74, 1
  s_lshr_b32 s74, s74, 1
  s_lshr_b32 s75, s74, 1
  s_add_u32 s75, s75, 1
  s_sub_u32 s76, 0, s75
  s_bitcmp1_b32 s74, 0
  s_cselect_b32 s75, s75, s76
  v_add_u32 v5, s75, v9
  v_mul_i32_i24 v12, 1152, v5
  v_add_u32 v98, v12, v7
  v_cmp_gt_i32 vcc, 0, v5
  s_nop 1
  v_cndmask_b32 v98, v98, v11, vcc
  v_add_u32 v5, s75, v10
  v_mul_i32_i24 v12, 1152, v5
  v_add_u32 v99, v12, v8
  v_cmp_gt_i32 vcc, 0, v5
  s_nop 1
  v_cndmask_b32 v99, v99, v11, vcc
  s_mov_b32 s74, 2
  s_lshr_b32 s74, s74, 1
  s_lshr_b32 s75, s74, 1
  s_add_u32 s75, s75, 1
  s_sub_u32 s76, 0, s75
  s_bitcmp1_b32 s74, 0
  s_cselect_b32 s75, s75, s76
  v_add_u32 v5, s75, v9
  v_mul_i32_i24 v12, 1152, v5
  v_add_u32 v100, v12, v7
  v_cmp_gt_i32 vcc, 0, v5
  s_nop 1
  v_cndmask_b32 v100, v100, v11, vcc
  v_add_u32 v5, s75, v10
  v_mul_i32_i24 v12, 1152, v5
  v_add_u32 v101, v12, v8
  v_cmp_gt_i32 vcc, 0, v5
  s_nop 1
  v_cndmask_b32 v101, v101, v11, vcc
  s_mov_b32 s74, 3
  s_lshr_b32 s74, s74, 1
  s_lshr_b32 s75, s74, 1
  s_add_u32 s75, s75, 1
  s_sub_u32 s76, 0, s75
  s_bitcmp1_b32 s74, 0
  s_cselect_b32 s75, s75, s76
  v_add_u32 v5, s75, v9
  v_mul_i32_i24 v12, 1152, v5
  v_add_u32 v102, v12, v7
  v_cmp_gt_i32 vcc, 0, v5
  s_nop 1
  v_cndmask_b32 v102, v102, v11, vcc
  v_add_u32 v5, s75, v10
  v_mul_i32_i24 v12, 1152, v5
  v_add_u32 v103, v12, v8
  v_cmp_gt_i32 vcc, 0, v5
  s_nop 1
  v_cndmask_b32 v103, v103, v11, vcc
  s_mov_b32 s74, 4
  s_lshr_b32 s74, s74, 1
  s_lshr_b32 s75, s74, 1
  s_add_u32 s75, s75, 1
  s_sub_u32 s76, 0, s75
  s_bitcmp1_b32 s74, 0
  s_cselect_b32 s75, s75, s76
  v_add_u32 v5, s75, v9
  v_mul_i32_i24 v12, 1152, v5
  v_add_u32 v104, v12, v7
  v_cmp_gt_i32 vcc, 0, v5
  s_nop 1
  v_cndmask_b32 v104, v104, v11, vcc
  v_add_u32 v5, s75, v10
  v_mul_i32_i24 v12, 1152, v5
  v_add_u32 v105, v12, v8
  v_cmp_gt_i32 vcc, 0, v5
  s_nop 1
  v_cndmask_b32 v105, v105, v11, vcc
  s_mov_b32 s74, 5
  s_lshr_b32 s74, s74, 1
  s_lshr_b32 s75, s74, 1
  s_add_u32 s75, s75, 1
  s_sub_u32 s76, 0, s75
  s_bitcmp1_b32 s74, 0
  s_cselect_b32 s75, s75, s76
  v_add_u32 v5, s75, v9
  v_mul_i32_i24 v12, 1152, v5
  v_add_u32 v106, v12, v7
  v_cmp_gt_i32 vcc, 0, v5
  s_nop 1
  v_cndmask_b32 v106, v106, v11, vcc
  v_add_u32 v5, s75, v10
  v_mul_i32_i24 v12, 1152, v5
  v_add_u32 v107, v12, v8
  v_cmp_gt_i32 vcc, 0, v5
  s_nop 1
  v_cndmask_b32 v107, v107, v11, vcc
  s_mov_b32 s74, 6
  s_lshr_b32 s74, s74, 1
  s_lshr_b32 s75, s74, 1
  s_add_u32 s75, s75, 1
  s_sub_u32 s76, 0, s75
  s_bitcmp1_b32 s74, 0
  s_cselect_b32 s75, s75, s76
  v_add_u32 v5, s75, v9
  v_mul_i32_i24 v12, 1152, v5
  v_add_u32 v108, v12, v7
  v_cmp_gt_i32 vcc, 0, v5
  s_nop 1
  v_cndmask_b32 v108, v108, v11, vcc
  v_add_u32 v5, s75, v10
  v_mul_i32_i24 v12, 1152, v5
  v_add_u32 v109, v12, v8
  v_cmp_gt_i32 vcc, 0, v5
  s_nop 1
  v_cndmask_b32 v109, v109, v11, vcc
  s_mov_b32 s74, 7
  s_lshr_b32 s74, s74, 1
  s_lshr_b32 s75, s74, 1
  s_add_u32 s75, s75, 1
  s_sub_u32 s76, 0, s75
  s_bitcmp1_b32 s74, 0
  s_cselect_b32 s75, s75, s76
  v_add_u32 v5, s75, v9
  v_mul_i32_i24 v12, 1152, v5
  v_add_u32 v110, v12, v7
  v_cmp_gt_i32 vcc, 0, v5
  s_nop 1
  v_cndmask_b32 v110, v110, v11, vcc
  v_add_u32 v5, s75, v10
  v_mul_i32_i24 v12, 1152, v5
  v_add_u32 v111, v12, v8
  v_cmp_gt_i32 vcc, 0, v5
  s_nop 1
  v_cndmask_b32 v111, v111, v11, vcc
  v_mov_b32 v112, 1065369472
  v_mov_b32 v113, 1065369472
  v_mov_b32 v114, 1065369472
  v_mov_b32 v115, 1065369472
  v_mov_b32 v116, 0
  v_mov_b32 v117, 0
  v_mov_b32 v118, 0
  v_mov_b32 v119, 0
  v_mov_b32 v120, 0
  v_mov_b32 v121, 0
  v_mov_b32 v122, 0
  v_mov_b32 v123, 0
  v_mov_b32 v124, 0
  v_mov_b32 v125, 0
  v_mov_b32 v126, 0
  v_mov_b32 v127, 0
  v_mov_b32 v128, 0
  v_mov_b32 v129, 0
  v_mov_b32 v130, 0
  v_mov_b32 v131, 0
  v_mov_b32 v132, 0
  v_mov_b32 v133, 0
  v_mov_b32 v134, 0
  v_mov_b32 v135, 0
  v_mov_b32 v136, 0
  v_mov_b32 v137, 0
  v_mov_b32 v138, 0
  v_mov_b32 v139, 0
  v_lshrrev_b32 v5, 2, v2
  v_and_b32 v11, 1, v3
  v_lshl_add_u32 v5, v11, 3, v5
  v_mul_u32_u24 v5, 192, v5
  v_lshrrev_b32 v12, 1, v3
  v_mul_u32_u24 v12, 12288, v12
  v_and_b32 v13, 3, v1
  v_lshl_add_u32 v5, v13, 3, v5
  v_add3_u32 v5, v5, v12, s93
  v_xor_b32 v12, 0, v11
  v_lshl_add_u32 v188, v12, 5, v5
  v_xor_b32 v12, 1, v11
  v_lshl_add_u32 v189, v12, 5, v5
  v_xor_b32 v12, 2, v11
  v_lshl_add_u32 v190, v12, 5, v5
  v_xor_b32 v12, 3, v11
  v_lshl_add_u32 v191, v12, 5, v5
  v_xor_b32 v12, 4, v11
  v_lshl_add_u32 v192, v12, 5, v5
  v_xor_b32 v12, 5, v11
  v_lshl_add_u32 v193, v12, 5, v5
  v_cmp_eq_u32 s[70:71], 0, v2
  s_mul_i32 s74, s79, 384
  s_add_u32 s74, s74, 147456
  v_lshlrev_b32 v12, 4, v3
  v_add_u32 v194, s74, v12
  s_barrier
  s_mov_b32 s3, 0
  s_lshl_b32 s3, s3, 7
  s_add_u32 m0, s92, 65536
  s_add_u32 s86, s3, 0
  buffer_load_dwordx4 v96, s[40:43], s86 offen sc1 lds
  s_add_u32 m0, s92, 66560
  s_add_u32 s86, s3, 0
  buffer_load_dwordx4 v97, s[40:43], s86 offen sc1 lds
  s_mov_b32 s3, 1
  s_lshl_b32 s3, s3, 7
  s_add_u32 m0, s92, 73728
  s_add_u32 s86, s3, 0
  buffer_load_dwordx4 v98, s[40:43], s86 offen sc1 lds
  s_add_u32 m0, s92, 74752
  s_add_u32 s86, s3, 0
  buffer_load_dwordx4 v99, s[40:43], s86 offen sc1 lds
  s_mov_b32 s3, 2
  s_lshl_b32 s3, s3, 7
  s_add_u32 m0, s92, 81920
  s_add_u32 s86, s3, 0
  buffer_load_dwordx4 v100, s[40:43], s86 offen sc1 lds
  s_add_u32 m0, s92, 82944
  s_add_u32 s86, s3, 0
  buffer_load_dwordx4 v101, s[40:43], s86 offen sc1 lds
  s_mov_b32 s3, 3
  s_lshl_b32 s3, s3, 7
  s_add_u32 m0, s92, 90112
  s_add_u32 s86, s3, 0
  buffer_load_dwordx4 v102, s[40:43], s86 offen sc1 lds
  s_add_u32 m0, s92, 91136
  s_add_u32 s86, s3, 0
  buffer_load_dwordx4 v103, s[40:43], s86 offen sc1 lds
  s_mov_b32 s3, 7
  s_lshl_b32 s3, s3, 16
  s_add_u32 m0, s92, 57344
  s_add_u32 s86, s3, 0
  buffer_load_dwordx4 v18, s[16:19], s86 offen lds
  s_add_u32 m0, s92, 58368
  s_add_u32 s86, s3, 0
  buffer_load_dwordx4 v19, s[16:19], s86 offen lds
  s_waitcnt vmcnt(8)
  s_waitcnt vmcnt(0)
  s_barrier
  s_mov_b32 s3, 4
  s_lshl_b32 s3, s3, 7
  s_add_u32 m0, s92, 98304
  s_add_u32 s86, s3, 0
  buffer_load_dwordx4 v104, s[40:43], s86 offen sc1 lds
  s_add_u32 m0, s92, 99328
  s_add_u32 s86, s3, 0
  buffer_load_dwordx4 v105, s[40:43], s86 offen sc1 lds
  s_barrier
  s_mov_b32 s3, 5
  s_lshl_b32 s3, s3, 7
  s_add_u32 m0, s92, 106496
  s_add_u32 s86, s3, 0
  buffer_load_dwordx4 v106, s[40:43], s86 offen sc1 lds
  s_add_u32 m0, s92, 107520
  s_add_u32 s86, s3, 0
  buffer_load_dwordx4 v107, s[40:43], s86 offen sc1 lds
  s_mov_b32 s3, 6
  s_lshl_b32 s3, s3, 7
  s_add_u32 m0, s92, 114688
  s_add_u32 s86, s3, 0
  buffer_load_dwordx4 v108, s[40:43], s86 offen sc1 lds
  s_add_u32 m0, s92, 115712
  s_add_u32 s86, s3, 0
  buffer_load_dwordx4 v109, s[40:43], s86 offen sc1 lds
  s_barrier
  s_mov_b32 s3, 7
  s_lshl_b32 s3, s3, 7
  s_add_u32 m0, s92, 122880
  s_add_u32 s86, s3, 0
  buffer_load_dwordx4 v110, s[40:43], s86 offen sc1 lds
  s_add_u32 m0, s92, 123904
  s_add_u32 s86, s3, 0
  buffer_load_dwordx4 v111, s[40:43], s86 offen sc1 lds
  s_add_u32 s3, s79, 0
  s_mul_i32 s3, s3, 44032
  s_add_u32 m0, s93, 0
  s_add_u32 s86, s3, 0
  buffer_load_dwordx4 v30, s[24:27], s86 offen lds
  s_add_u32 m0, s93, 1024
  s_add_u32 s86, s3, 0
  buffer_load_dwordx4 v31, s[24:27], s86 offen lds
  s_add_u32 m0, s93, 2048
  s_add_u32 s86, s3, 0
  buffer_load_dwordx4 v32, s[24:27], s86 offen lds
  s_waitcnt vmcnt(7)
  s_barrier
  s_add_u32 s3, s79, 4
  s_mul_i32 s3, s3, 44032
  s_add_u32 m0, s93, 12288
  s_add_u32 s86, s3, 0
  buffer_load_dwordx4 v30, s[24:27], s86 offen lds
  s_add_u32 m0, s93, 13312
  s_add_u32 s86, s3, 0
  buffer_load_dwordx4 v31, s[24:27], s86 offen lds
  s_add_u32 m0, s93, 14336
  s_add_u32 s86, s3, 0
  buffer_load_dwordx4 v32, s[24:27], s86 offen lds
  s_waitcnt vmcnt(6)
  s_barrier
  s_add_u32 s3, s79, 8
  s_mul_i32 s3, s3, 44032
  s_add_u32 m0, s93, 24576
  s_add_u32 s86, s3, 0
  buffer_load_dwordx4 v30, s[24:27], s86 offen lds
  s_add_u32 m0, s93, 25600
  s_add_u32 s86, s3, 0
  buffer_load_dwordx4 v31, s[24:27], s86 offen lds
  s_add_u32 m0, s93, 26624
  s_add_u32 s86, s3, 0
  buffer_load_dwordx4 v32, s[24:27], s86 offen lds
  s_barrier
  s_and_b32 s77, s90, 3
  s_mov_b32 s77, 0
  s_add_u32 s74, s77, 0
  s_cmp_ge_u32 s74, 5
  s_cselect_b32 s75, 5, 0
  s_sub_u32 s74, s74, s75
  s_add_u32 s74, s74, 3
  s_lshl_b32 s3, s74, 2
  s_add_u32 s3, s3, s79
  s_mul_i32 s3, s3, 44032
  s_mul_i32 s65, s74, 12288
  s_add_u32 m0, s93, s65
  s_add_u32 s86, s3, 0
  buffer_load_dwordx4 v30, s[24:27], s86 offen lds
  s_add_u32 m0, s93, s65
  s_add_u32 m0, m0, 1024
  s_add_u32 s86, s3, 0
  buffer_load_dwordx4 v31, s[24:27], s86 offen lds
  s_add_u32 m0, s93, s65
  s_add_u32 m0, m0, 2048
  s_add_u32 s86, s3, 0
  buffer_load_dwordx4 v32, s[24:27], s86 offen lds
  s_add_u32 s74, s77, 1
  s_cmp_ge_u32 s74, 5
  s_cselect_b32 s75, 5, 0
  s_sub_u32 s74, s74, s75
  s_add_u32 s74, s74, 3
  s_lshl_b32 s3, s74, 2
  s_add_u32 s3, s3, s79
  s_mul_i32 s3, s3, 44032
  s_mul_i32 s65, s74, 12288
  s_add_u32 m0, s93, s65
  s_add_u32 s86, s3, 0
  buffer_load_dwordx4 v30, s[24:27], s86 offen lds
  s_add_u32 m0, s93, s65
  s_add_u32 m0, m0, 1024
  s_add_u32 s86, s3, 0
  buffer_load_dwordx4 v31, s[24:27], s86 offen lds
  s_add_u32 m0, s93, s65
  s_add_u32 m0, m0, 2048
  s_add_u32 s86, s3, 0
  buffer_load_dwordx4 v32, s[24:27], s86 offen lds
  s_barrier
  s_add_u32 s74, s77, 2
  s_cmp_ge_u32 s74, 5
  s_cselect_b32 s75, 5, 0
  s_sub_u32 s74, s74, s75
  s_add_u32 s74, s74, 3
  s_lshl_b32 s3, s74, 2
  s_add_u32 s3, s3, s79
  s_mul_i32 s3, s3, 44032
  s_mul_i32 s65, s74, 12288
  s_add_u32 m0, s93, s65
  s_add_u32 s86, s3, 0
  buffer_load_dwordx4 v30, s[24:27], s86 offen lds
  s_add_u32 m0, s93, s65
  s_add_u32 m0, m0, 1024
  s_add_u32 s86, s3, 0
  buffer_load_dwordx4 v31, s[24:27], s86 offen lds
  s_add_u32 m0, s93, s65
  s_add_u32 m0, m0, 2048
  s_add_u32 s86, s3, 0
  buffer_load_dwordx4 v32, s[24:27], s86 offen lds
  s_add_u32 s74, s77, 3
  s_cmp_ge_u32 s74, 5
  s_cselect_b32 s75, 5, 0
  s_sub_u32 s74, s74, s75
  s_add_u32 s74, s74, 3
  s_lshl_b32 s3, s74, 2
  s_add_u32 s3, s3, s79
  s_mul_i32 s3, s3, 44032
  s_mul_i32 s65, s74, 12288
  s_add_u32 m0, s93, s65
  s_add_u32 s86, s3, 0
  buffer_load_dwordx4 v30, s[24:27], s86 offen lds
  s_add_u32 m0, s93, s65
  s_add_u32 m0, m0, 1024
  s_add_u32 s86, s3, 0
  buffer_load_dwordx4 v31, s[24:27], s86 offen lds
  s_add_u32 m0, s93, s65
  s_add_u32 m0, m0, 2048
  s_add_u32 s86, s3, 0
  buffer_load_dwordx4 v32, s[24:27], s86 offen lds
  s_add_u32 s74, s77, 4
  s_cmp_ge_u32 s74, 5
  s_cselect_b32 s75, 5, 0
  s_sub_u32 s74, s74, s75
  s_add_u32 s74, s74, 3
  s_lshl_b32 s3, s74, 2
  s_add_u32 s3, s3, s79
  s_mul_i32 s3, s3, 44032
  s_mul_i32 s65, s74, 12288
  s_add_u32 m0, s93, s65
  s_add_u32 s86, s3, 0
  buffer_load_dwordx4 v30, s[24:27], s86 offen lds
  s_add_u32 m0, s93, s65
  s_add_u32 m0, m0, 1024
  s_add_u32 s86, s3, 0
  buffer_load_dwordx4 v31, s[24:27], s86 offen lds
  s_add_u32 m0, s93, s65
  s_add_u32 m0, m0, 2048
  s_add_u32 s86, s3, 0
  buffer_load_dwordx4 v32, s[24:27], s86 offen lds
  s_waitcnt vmcnt(18)
  ds_read_b64_tr_b16 v[140:141], v188 offset:0
  ds_read_b64_tr_b16 v[142:143], v188 offset:768
  ds_read_b64_tr_b16 v[144:145], v189 offset:0
  ds_read_b64_tr_b16 v[146:147], v189 offset:768
  ds_read_b64_tr_b16 v[148:149], v190 offset:0
  ds_read_b64_tr_b16 v[150:151], v190 offset:768
  ds_read_b64_tr_b16 v[152:153], v191 offset:0
  ds_read_b64_tr_b16 v[154:155], v191 offset:768
  ds_read_b64_tr_b16 v[156:157], v192 offset:0
  ds_read_b64_tr_b16 v[158:159], v192 offset:768
  ds_read_b64_tr_b16 v[160:161], v193 offset:0
  ds_read_b64_tr_b16 v[162:163], v193 offset:768
  s_waitcnt vmcnt(12)
  ds_read_b64_tr_b16 v[164:165], v188 offset:24576
  ds_read_b64_tr_b16 v[166:167], v188 offset:25344
  ds_read_b64_tr_b16 v[168:169], v189 offset:24576
  ds_read_b64_tr_b16 v[170:171], v189 offset:25344
  ds_read_b64_tr_b16 v[172:173], v190 offset:24576
  ds_read_b64_tr_b16 v[174:175], v190 offset:25344
  ds_read_b64_tr_b16 v[176:177], v191 offset:24576
  ds_read_b64_tr_b16 v[178:179], v191 offset:25344
  ds_read_b64_tr_b16 v[180:181], v192 offset:24576
  ds_read_b64_tr_b16 v[182:183], v192 offset:25344
  ds_read_b64_tr_b16 v[184:185], v193 offset:24576
  ds_read_b64_tr_b16 v[186:187], v193 offset:25344
  s_waitcnt lgkmcnt(15)
  v_mfma_f32_16x16x32_bf16 v[116:119], v[140:143], v[112:115], v[116:119]
  v_mfma_f32_16x16x32_bf16 v[120:123], v[144:147], v[112:115], v[120:123]
  v_mfma_f32_16x16x32_bf16 v[124:127], v[148:151], v[112:115], v[124:127]
  v_mfma_f32_16x16x32_bf16 v[128:131], v[152:155], v[112:115], v[128:131]
  s_waitcnt lgkmcnt(14)
  v_mfma_f32_16x16x32_bf16 v[132:135], v[156:159], v[112:115], v[132:135]
  s_waitcnt lgkmcnt(12)
  v_mfma_f32_16x16x32_bf16 v[136:139], v[160:163], v[112:115], v[136:139]
  v_add_u32 v188, 49152, v188
  v_add_u32 v189, 49152, v189
  v_add_u32 v190, 49152, v190
  v_add_u32 v191, 49152, v191
  v_add_u32 v192, 49152, v192
  v_add_u32 v193, 49152, v193
  s_waitcnt vmcnt(6)
  ds_read_b64_tr_b16 v[140:141], v188 offset:0
  ds_read_b64_tr_b16 v[142:143], v188 offset:768
  ds_read_b64_tr_b16 v[144:145], v189 offset:0
  ds_read_b64_tr_b16 v[146:147], v189 offset:768
  ds_read_b64_tr_b16 v[148:149], v190 offset:0
  ds_read_b64_tr_b16 v[150:151], v190 offset:768
  ds_read_b64_tr_b16 v[152:153], v191 offset:0
  ds_read_b64_tr_b16 v[154:155], v191 offset:768
  ds_read_b64_tr_b16 v[156:157], v192 offset:0
  ds_read_b64_tr_b16 v[158:159], v192 offset:768
  ds_read_b64_tr_b16 v[160:161], v193 offset:0
  ds_read_b64_tr_b16 v[162:163], v193 offset:768
  s_waitcnt lgkmcnt(15)
  v_mfma_f32_16x16x32_bf16 v[116:119], v[164:167], v[112:115], v[116:119]
  v_mfma_f32_16x16x32_bf16 v[120:123], v[168:171], v[112:115], v[120:123]
  v_mfma_f32_16x16x32_bf16 v[124:127], v[172:175], v[112:115], v[124:127]
  v_mfma_f32_16x16x32_bf16 v[128:131], v[176:179], v[112:115], v[128:131]
  s_waitcnt lgkmcnt(14)
  v_mfma_f32_16x16x32_bf16 v[132:135], v[180:183], v[112:115], v[132:135]
  s_waitcnt lgkmcnt(12)
  v_mfma_f32_16x16x32_bf16 v[136:139], v[184:187], v[112:115], v[136:139]
  s_waitcnt vmcnt(0)
  ds_read_b64_tr_b16 v[164:165], v188 offset:24576
  ds_read_b64_tr_b16 v[166:167], v188 offset:25344
  ds_read_b64_tr_b16 v[168:169], v189 offset:24576
  ds_read_b64_tr_b16 v[170:171], v189 offset:25344
  ds_read_b64_tr_b16 v[172:173], v190 offset:24576
  ds_read_b64_tr_b16 v[174:175], v190 offset:25344
  ds_read_b64_tr_b16 v[176:177], v191 offset:24576
  ds_read_b64_tr_b16 v[178:179], v191 offset:25344
  ds_read_b64_tr_b16 v[180:181], v192 offset:24576
  ds_read_b64_tr_b16 v[182:183], v192 offset:25344
  ds_read_b64_tr_b16 v[184:185], v193 offset:24576
  ds_read_b64_tr_b16 v[186:187], v193 offset:25344
  s_waitcnt lgkmcnt(15)
  v_mfma_f32_16x16x32_bf16 v[116:119], v[140:143], v[112:115], v[116:119]
  v_mfma_f32_16x16x32_bf16 v[120:123], v[144:147], v[112:115], v[120:123]
  v_mfma_f32_16x16x32_bf16 v[124:127], v[148:151], v[112:115], v[124:127]
  v_mfma_f32_16x16x32_bf16 v[128:131], v[152:155], v[112:115], v[128:131]
  s_waitcnt lgkmcnt(14)
  v_mfma_f32_16x16x32_bf16 v[132:135], v[156:159], v[112:115], v[132:135]
  s_waitcnt lgkmcnt(12)
  v_mfma_f32_16x16x32_bf16 v[136:139], v[160:163], v[112:115], v[136:139]
  s_waitcnt lgkmcnt(10)
  v_mfma_f32_16x16x32_bf16 v[116:119], v[164:167], v[112:115], v[116:119]
  s_waitcnt lgkmcnt(8)
  v_mfma_f32_16x16x32_bf16 v[120:123], v[168:171], v[112:115], v[120:123]
  s_waitcnt lgkmcnt(6)
  v_mfma_f32_16x16x32_bf16 v[124:127], v[172:175], v[112:115], v[124:127]
  s_waitcnt lgkmcnt(4)
  v_mfma_f32_16x16x32_bf16 v[128:131], v[176:179], v[112:115], v[128:131]
  s_waitcnt lgkmcnt(2)
  v_mfma_f32_16x16x32_bf16 v[132:135], v[180:183], v[112:115], v[132:135]
  s_waitcnt lgkmcnt(0)
  v_mfma_f32_16x16x32_bf16 v[136:139], v[184:187], v[112:115], v[136:139]
  s_mov_b64 exec, s[70:71]
  ds_write_b128 v194, v[116:119] offset:0
  ds_write_b128 v194, v[120:123] offset:64
  ds_write_b128 v194, v[124:127] offset:128
  ds_write_b128 v194, v[128:131] offset:192
  s_nop 0
  ds_write_b128 v194, v[132:135] offset:256
  s_nop 0
  ds_write_b128 v194, v[136:139] offset:320
  s_mov_b64 exec, -1
  s_waitcnt lgkmcnt(0)
  s_barrier
  ds_read_b128 v[64:67], v40
  ds_read_b128 v[68:71], v41
  s_waitcnt lgkmcnt(1)
  buffer_store_dwordx4 v[64:67], v42, s[36:39], s63 offen sc1
  s_waitcnt lgkmcnt(0)
  buffer_store_dwordx4 v[68:71], v43, s[36:39], s63 offen sc1
  s_barrier
  s_cmp_eq_u32 s91, 15
  s_cbranch_scc1 LL_p3skip_5
  s_add_u32 m0, s94, 98304
  s_add_u32 s86, s62, 0
  buffer_load_dwordx4 v36, s[36:39], s86 offen sc1 lds
  s_add_u32 m0, s94, 99328
  s_add_u32 s86, s62, 0
  buffer_load_dwordx4 v37, s[36:39], s86 offen sc1 lds
  s_add_u32 m0, s94, 100352
  s_add_u32 s86, s62, 18432
  buffer_load_dwordx4 v36, s[36:39], s86 offen sc1 lds
  s_add_u32 m0, s94, 101376
  s_add_u32 s86, s62, 18432
  buffer_load_dwordx4 v37, s[36:39], s86 offen sc1 lds
  s_add_u32 m0, s94, 114688
  s_add_u32 s86, s62, 128
  buffer_load_dwordx4 v36, s[36:39], s86 offen sc1 lds
  s_add_u32 m0, s94, 115712
  s_add_u32 s86, s62, 128
  buffer_load_dwordx4 v37, s[36:39], s86 offen sc1 lds
  s_add_u32 m0, s94, 116736
  s_add_u32 s86, s62, 18560
  buffer_load_dwordx4 v36, s[36:39], s86 offen sc1 lds
  s_add_u32 m0, s94, 117760
  s_add_u32 s86, s62, 18560
  buffer_load_dwordx4 v37, s[36:39], s86 offen sc1 lds
  s_add_u32 m0, s94, 131072
  s_add_u32 s86, s62, 256
  buffer_load_dwordx4 v36, s[36:39], s86 offen sc1 lds
  s_add_u32 m0, s94, 132096
  s_add_u32 s86, s62, 256
  buffer_load_dwordx4 v37, s[36:39], s86 offen sc1 lds
  s_add_u32 m0, s94, 133120
  s_add_u32 s86, s62, 18688
  buffer_load_dwordx4 v36, s[36:39], s86 offen sc1 lds
  s_add_u32 m0, s94, 134144
  s_add_u32 s86, s62, 18688
  buffer_load_dwordx4 v37, s[36:39], s86 offen sc1 lds
  s_waitcnt vmcnt(8)
  s_add_u32 s74, s49, 4
  v_mov_b32 v13, s74
  v_mov_b32 v14, s67
  s_mov_b64 exec, 1
  buffer_store_dword v13, v14, s[36:39], 0 offen sc1
  s_mov_b64 exec, -1
  s_barrier
  s_add_u32 m0, s94, 147456
  s_add_u32 s86, s62, 384
  buffer_load_dwordx4 v36, s[36:39], s86 offen sc1 lds
  s_add_u32 m0, s94, 148480
  s_add_u32 s86, s62, 384
  buffer_load_dwordx4 v37, s[36:39], s86 offen sc1 lds
  s_add_u32 m0, s94, 149504
  s_add_u32 s86, s62, 18816
  buffer_load_dwordx4 v36, s[36:39], s86 offen sc1 lds
  s_add_u32 m0, s94, 150528
  s_add_u32 s86, s62, 18816
  buffer_load_dwordx4 v37, s[36:39], s86 offen sc1 lds
  s_waitcnt vmcnt(8)
  s_barrier
  s_add_u32 m0, s94, 98304
  s_add_u32 s86, s62, 512
  buffer_load_dwordx4 v36, s[36:39], s86 offen sc1 lds
  s_add_u32 m0, s94, 99328
  s_add_u32 s86, s62, 512
  buffer_load_dwordx4 v37, s[36:39], s86 offen sc1 lds
  s_add_u32 m0, s94, 100352
  s_add_u32 s86, s62, 18944
  buffer_load_dwordx4 v36, s[36:39], s86 offen sc1 lds
  s_add_u32 m0, s94, 101376
  s_add_u32 s86, s62, 18944
  buffer_load_dwordx4 v37, s[36:39], s86 offen sc1 lds
  buffer_load_dwordx2 v[64:65], v51, s[36:39], 0 offen offset:0 sc1
  buffer_load_dwordx2 v[66:67], v51, s[36:39], 0 offen offset:512 sc1
  buffer_load_dwordx2 v[68:69], v51, s[36:39], 0 offen offset:1024 sc1
  buffer_load_dwordx2 v[70:71], v51, s[36:39], 0 offen offset:1536 sc1
  buffer_load_dwordx2 v[72:73], v51, s[36:39], 0 offen offset:2048 sc1
  buffer_load_dwordx2 v[74:75], v51, s[36:39], 0 offen offset:2560 sc1
  buffer_load_dwordx2 v[76:77], v51, s[36:39], 0 offen offset:3072 sc1
  buffer_load_dwordx2 v[78:79], v51, s[36:39], 0 offen offset:3584 sc1
  s_waitcnt vmcnt(16)
  s_barrier
  s_add_u32 m0, s94, 114688
  s_add_u32 s86, s62, 640
  buffer_load_dwordx4 v36, s[36:39], s86 offen sc1 lds
  s_add_u32 m0, s94, 115712
  s_add_u32 s86, s62, 640
  buffer_load_dwordx4 v37, s[36:39], s86 offen sc1 lds
  s_add_u32 m0, s94, 116736
  s_add_u32 s86, s62, 19072
  buffer_load_dwordx4 v36, s[36:39], s86 offen sc1 lds
  s_add_u32 m0, s94, 117760
  s_add_u32 s86, s62, 19072
  buffer_load_dwordx4 v37, s[36:39], s86 offen sc1 lds
  s_waitcnt vmcnt(16)
  s_barrier
  s_add_u32 m0, s94, 131072
  s_add_u32 s86, s62, 768
  buffer_load_dwordx4 v36, s[36:39], s86 offen sc1 lds
  s_add_u32 m0, s94, 132096
  s_add_u32 s86, s62, 768
  buffer_load_dwordx4 v37, s[36:39], s86 offen sc1 lds
  s_add_u32 m0, s94, 133120
  s_add_u32 s86, s62, 19200
  buffer_load_dwordx4 v36, s[36:39], s86 offen sc1 lds
  s_add_u32 m0, s94, 134144
  s_add_u32 s86, s62, 19200
  buffer_load_dwordx4 v37, s[36:39], s86 offen sc1 lds
  buffer_load_dwordx4 v[88:91], v45, s[36:39], 0 offen sc1
  s_waitcnt vmcnt(17)
  s_barrier
  s_add_u32 m0, s94, 147456
  s_add_u32 s86, s62, 896
  buffer_load_dwordx4 v36, s[36:39], s86 offen sc1 lds
  s_add_u32 m0, s94, 148480
  s_add_u32 s86, s62, 896
  buffer_load_dwordx4 v37, s[36:39], s86 offen sc1 lds
  s_add_u32 m0, s94, 149504
  s_add_u32 s86, s62, 19328
  buffer_load_dwordx4 v36, s[36:39], s86 offen sc1 lds
  s_add_u32 m0, s94, 150528
  s_add_u32 s86, s62, 19328
  buffer_load_dwordx4 v37, s[36:39], s86 offen sc1 lds
  s_waitcnt vmcnt(9)
  s_barrier
  v_add_f32 v64, v64, v66
  v_add_f32 v65, v65, v67
  v_add_f32 v64, v64, v68
  v_add_f32 v65, v65, v69
  v_add_f32 v64, v64, v70
  v_add_f32 v65, v65, v71
  v_add_f32 v72, v72, v74
  v_add_f32 v73, v73, v75
  v_add_f32 v72, v72, v76
  v_add_f32 v73, v73, v77
  v_add_f32 v72, v72, v78
  v_add_f32 v73, v73, v79
  v_add_f32 v64, v64, v72
  v_add_f32 v65, v65, v73
  v_mov_b32 v66, v64
  v_mov_b32 v67, v65
  s_nop 0
  v_permlane32_swap_b32 v64, v66
  v_permlane32_swap_b32 v65, v67
  v_add_f32 v64, v64, v66
  v_add_f32 v65, v65, v67
  v_mul_f32 v64, 989855744, v64
  v_mul_f32 v65, 989855744, v65
  v_fma_f32 v65, -v64, v64, v65
  v_max_f32 v65, 0, v65
  v_add_f32 v65, 925353388, v65
  v_rsq_f32 v66, v65
  s_nop 0
  v_mul_f32 v67, v65, v66
  v_mul_f32 v68, 3222493025, v66
  v_mul_f32 v69, v66, v66
  v_mul_f32 v69, v69, v66
  v_mul_f32 v69, 3184710632, v69
  ds_write_b32 v52, v64
  ds_write_b32 v52, v68 offset:512
  ds_write_b32 v52, v69 offset:1024
  ds_write_b32 v52, v67 offset:1536
  s_waitcnt lgkmcnt(0)
  s_waitcnt vmcnt(4)
  s_add_u32 s74, s49, 4
  s_mov_b32 s75, 0
  s_branch LL_pk_9
LL_pl_7:
  buffer_load_dwordx4 v[88:91], v45, s[36:39], 0 offen sc1
  s_waitcnt vmcnt(0)
LL_pk_9:
  v_subrev_u32 v88, s74, v88
  v_subrev_u32 v89, s74, v89
  v_subrev_u32 v90, s74, v90
  v_subrev_u32 v91, s74, v91
  v_max3_u32 v13, v88, v89, v90
  v_max_u32 v13, v13, v91
  v_cmp_ge_u32 vcc, 3, v13
  s_add_u32 s75, s75, 1
  s_nop 2
  s_cmp_eq_u64 vcc, exec
  s_cbranch_scc1 LL_pd_8
  s_cmp_lt_u32 s75, 400000
  s_cbranch_scc1 LL_pl_7
LL_pd_8:
  s_barrier
  s_add_u32 m0, s92, 114688
  s_add_u32 s86, s63, 256
  buffer_load_dwordx4 v53, s[36:39], s86 offen sc1 lds
  s_add_u32 m0, s92, 115712
  s_add_u32 s86, s63, 256
  buffer_load_dwordx4 v54, s[36:39], s86 offen sc1 lds
  s_add_u32 m0, s92, 122880
  s_add_u32 s86, s63, 384
  buffer_load_dwordx4 v53, s[36:39], s86 offen sc1 lds
  s_add_u32 m0, s92, 123904
  s_add_u32 s86, s63, 384
  buffer_load_dwordx4 v54, s[36:39], s86 offen sc1 lds
  s_waitcnt vmcnt(4)
  s_barrier
  s_add_u32 m0, s92, 131072
  s_add_u32 s86, s63, 512
  buffer_load_dwordx4 v53, s[36:39], s86 offen sc1 lds
  s_add_u32 m0, s92, 132096
  s_add_u32 s86, s63, 512
  buffer_load_dwordx4 v54, s[36:39], s86 offen sc1 lds
  s_add_u32 m0, s92, 139264
  s_add_u32 s86, s63, 640
  buffer_load_dwordx4 v53, s[36:39], s86 offen sc1 lds
  s_add_u32 m0, s92, 140288
  s_add_u32 s86, s63, 640
  buffer_load_dwordx4 v54, s[36:39], s86 offen sc1 lds
  s_add_u32 m0, s92, 98304
  s_add_u32 s86, s63, 0
  buffer_load_dwordx4 v53, s[36:39], s86 offen sc1 lds
  s_add_u32 m0, s92, 99328
  s_add_u32 s86, s63, 0
  buffer_load_dwordx4 v54, s[36:39], s86 offen sc1 lds
  s_add_u32 m0, s92, 106496
  s_add_u32 s86, s63, 128
  buffer_load_dwordx4 v53, s[36:39], s86 offen sc1 lds
  s_add_u32 m0, s92, 107520
  s_add_u32 s86, s63, 128
  buffer_load_dwordx4 v54, s[36:39], s86 offen sc1 lds
  s_branch LL_p3join_6
LL_p3skip_5:
  s_waitcnt vmcnt(0)
  s_add_u32 s74, s49, 4
  v_mov_b32 v13, s74
  v_mov_b32 v14, s67
  s_mov_b64 exec, 1
  buffer_store_dword v13, v14, s[36:39], 0 offen sc1
  s_mov_b64 exec, -1
  s_add_u32 s74, s49, 4
  s_mov_b32 s75, 0
LL_pl_10:
  buffer_load_dwordx4 v[88:91], v45, s[36:39], 0 offen sc1
  s_waitcnt vmcnt(0)
LL_pk_12:
  v_subrev_u32 v88, s74, v88
  v_subrev_u32 v89, s74, v89
  v_subrev_u32 v90, s74, v90
  v_subrev_u32 v91, s74, v91
  v_max3_u32 v13, v88, v89, v90
  v_max_u32 v13, v13, v91
  v_cmp_ge_u32 vcc, 3, v13
  s_add_u32 s75, s75, 1
  s_nop 2
  s_cmp_eq_u64 vcc, exec
  s_cbranch_scc1 LL_pd_11
  s_cmp_lt_u32 s75, 400000
  s_cbranch_scc1 LL_pl_10
LL_pd_11:
  s_add_u32 m0, s92, 114688
  s_add_u32 s86, s63, 256
  buffer_load_dwordx4 v53, s[36:39], s86 offen sc1 lds
  s_add_u32 m0, s92, 115712
  s_add_u32 s86, s63, 256
  buffer_load_dwordx4 v54, s[36:39], s86 offen sc1 lds
  s_add_u32 m0, s92, 122880
  s_add_u32 s86, s63, 384
  buffer_load_dwordx4 v53, s[36:39], s86 offen sc1 lds
  s_add_u32 m0, s92, 123904
  s_add_u32 s86, s63, 384
  buffer_load_dwordx4 v54, s[36:39], s86 offen sc1 lds
  s_add_u32 m0, s92, 131072
  s_add_u32 s86, s63, 512
  buffer_load_dwordx4 v53, s[36:39], s86 offen sc1 lds
  s_add_u32 m0, s92, 132096
  s_add_u32 s86, s63, 512
  buffer_load_dwordx4 v54, s[36:39], s86 offen sc1 lds
  s_add_u32 m0, s92, 139264
  s_add_u32 s86, s63, 640
  buffer_load_dwordx4 v53, s[36:39], s86 offen sc1 lds
  s_add_u32 m0, s92, 140288
  s_add_u32 s86, s63, 640
  buffer_load_dwordx4 v54, s[36:39], s86 offen sc1 lds
  s_add_u32 m0, s92, 98304
  s_add_u32 s86, s63, 0
  buffer_load_dwordx4 v53, s[36:39], s86 offen sc1 lds
  s_add_u32 m0, s92, 99328
  s_add_u32 s86, s63, 0
  buffer_load_dwordx4 v54, s[36:39], s86 offen sc1 lds
  s_add_u32 m0, s92, 106496
  s_add_u32 s86, s63, 128
  buffer_load_dwordx4 v53, s[36:39], s86 offen sc1 lds
  s_add_u32 m0, s92, 107520
  s_add_u32 s86, s63, 128
  buffer_load_dwordx4 v54, s[36:39], s86 offen sc1 lds
  s_waitcnt vmcnt(0)
  s_barrier
  s_barrier
  s_barrier
  s_barrier
  s_barrier
  s_barrier
  s_barrier
  s_barrier
LL_p3join_6:
  s_barrier
  s_add_u32 m0, s92, 32768
  s_mov_b32 s86, 0
  buffer_load_dwordx4 v18, s[20:23], s86 offen lds
  s_add_u32 m0, s92, 33792
  s_mov_b32 s86, 0
  buffer_load_dwordx4 v19, s[20:23], s86 offen lds
  s_add_u32 m0, s92, 147456
  s_add_u32 s86, s63, 768
  buffer_load_dwordx4 v53, s[36:39], s86 offen sc1 lds
  s_add_u32 m0, s92, 148480
  s_add_u32 s86, s63, 768
  buffer_load_dwordx4 v54, s[36:39], s86 offen sc1 lds
  s_add_u32 m0, s92, 40960
  s_mov_b32 s86, 65536
  buffer_load_dwordx4 v18, s[20:23], s86 offen lds
  s_add_u32 m0, s92, 41984
  s_mov_b32 s86, 65536
  buffer_load_dwordx4 v19, s[20:23], s86 offen lds
  s_add_u32 m0, s92, 155648
  s_add_u32 s86, s63, 896
  buffer_load_dwordx4 v53, s[36:39], s86 offen sc1 lds
  s_add_u32 m0, s92, 156672
  s_add_u32 s86, s63, 896
  buffer_load_dwordx4 v54, s[36:39], s86 offen sc1 lds
  s_add_u32 m0, s92, 49152
  s_mov_b32 s86, 131072
  buffer_load_dwordx4 v18, s[20:23], s86 offen lds
  s_add_u32 m0, s92, 50176
  s_mov_b32 s86, 131072
  buffer_load_dwordx4 v19, s[20:23], s86 offen lds
  s_add_u32 m0, s92, 57344
  s_mov_b32 s86, 196608
  buffer_load_dwordx4 v18, s[20:23], s86 offen lds
  s_add_u32 m0, s92, 58368
  s_mov_b32 s86, 196608
  buffer_load_dwordx4 v19, s[20:23], s86 offen lds
  s_add_u32 m0, s92, 65536
  s_mov_b32 s86, 262144
  buffer_load_dwordx4 v18, s[20:23], s86 offen lds
  s_add_u32 m0, s92, 66560
  s_mov_b32 s86, 262144
  buffer_load_dwordx4 v19, s[20:23], s86 offen lds
  s_add_u32 m0, s92, 73728
  s_mov_b32 s86, 327680
  buffer_load_dwordx4 v18, s[20:23], s86 offen lds
  s_add_u32 m0, s92, 74752
  s_mov_b32 s86, 327680
  buffer_load_dwordx4 v19, s[20:23], s86 offen lds
  s_add_u32 m0, s92, 81920
  s_mov_b32 s86, 393216
  buffer_load_dwordx4 v18, s[20:23], s86 offen lds
  s_add_u32 m0, s92, 82944
  s_mov_b32 s86, 393216
  buffer_load_dwordx4 v19, s[20:23], s86 offen lds
  s_add_u32 m0, s92, 90112
  s_mov_b32 s86, 458752
  buffer_load_dwordx4 v18, s[20:23], s86 offen lds
  s_add_u32 m0, s92, 91136
  s_mov_b32 s86, 458752
  buffer_load_dwordx4 v19, s[20:23], s86 offen lds
  s_barrier
  s_cmp_eq_u32 s91, 15
  s_cbranch_scc1 LL_h2skip_13
  ds_read_b128 v[64:67], v44 offset:0
  ds_read_b128 v[68:71], v49 offset:0
  ds_read_b128 v[72:75], v50 offset:0
  s_mov_b32 s86, 0
  s_waitcnt lgkmcnt(2)
  buffer_store_dwordx4 v[64:67], v33, s[36:39], s86 offen sc1
  s_waitcnt lgkmcnt(1)
  buffer_store_dwordx4 v[68:71], v34, s[36:39], s86 offen sc1
  s_waitcnt lgkmcnt(0)
  buffer_store_dwordx4 v[72:75], v35, s[36:39], s86 offen sc1
LL_h2skip_13:
  s_barrier
  s_cmp_eq_u32 s91, 15
  s_cbranch_scc1 LL_h2skip_14
  ds_read_b128 v[76:79], v44 offset:6656
  ds_read_b128 v[80:83], v49 offset:6656
  ds_read_b128 v[84:87], v50 offset:6656
  s_mov_b32 s86, 90112
  s_waitcnt lgkmcnt(2)
  buffer_store_dwordx4 v[76:79], v33, s[36:39], s86 offen sc1
  s_waitcnt lgkmcnt(1)
  buffer_store_dwordx4 v[80:83], v34, s[36:39], s86 offen sc1
  s_waitcnt lgkmcnt(0)
  buffer_store_dwordx4 v[84:87], v35, s[36:39], s86 offen sc1
  s_waitcnt vmcnt(6)
  s_branch LL_h2join_15
LL_h2skip_14:
  s_waitcnt vmcnt(0)
LL_h2join_15:
  s_barrier
  s_add_u32 s3, s95, 0
  s_cmp_ge_u32 s3, 22
  s_cselect_b32 s78, 22, 0
  s_sub_u32 s3, s3, s78
  s_lshl_b32 s3, s3, 16
  s_add_u32 m0, s92, 0
  s_add_u32 s86, s3, 0
  buffer_load_dwordx4 v18, s[28:31], s86 offen lds
  s_add_u32 m0, s92, 1024
  s_add_u32 s86, s3, 0
  buffer_load_dwordx4 v19, s[28:31], s86 offen lds
  s_add_u32 s3, s95, 1
  s_cmp_ge_u32 s3, 22
  s_cselect_b32 s78, 22, 0
  s_sub_u32 s3, s3, s78
  s_lshl_b32 s3, s3, 16
  s_add_u32 m0, s92, 8192
  s_add_u32 s86, s3, 0
  buffer_load_dwordx4 v18, s[28:31], s86 offen lds
  s_add_u32 m0, s92, 9216
  s_add_u32 s86, s3, 0
  buffer_load_dwordx4 v19, s[28:31], s86 offen lds
  s_barrier
  s_waitcnt vmcnt(4)
  s_add_u32 s74, s49, 5
  v_mov_b32 v13, s74
  v_mov_b32 v14, s67
  s_mov_b64 exec, 1
  buffer_store_dword v13, v14, s[36:39], 0 offen sc1
  s_mov_b64 exec, -1
  s_add_u32 s3, s95, 2
  s_cmp_ge_u32 s3, 22
  s_cselect_b32 s78, 22, 0
  s_sub_u32 s3, s3, s78
  s_lshl_b32 s3, s3, 16
  s_add_u32 m0, s92, 16384
  s_add_u32 s86, s3, 0
  buffer_load_dwordx4 v18, s[28:31], s86 offen lds
  s_add_u32 m0, s92, 17408
  s_add_u32 s86, s3, 0
  buffer_load_dwordx4 v19, s[28:31], s86 offen lds
  s_add_u32 s3, s95, 3
  s_cmp_ge_u32 s3, 22
  s_cselect_b32 s78, 22, 0
  s_sub_u32 s3, s3, s78
  s_lshl_b32 s3, s3, 16
  s_add_u32 m0, s92, 24576
  s_add_u32 s86, s3, 0
  buffer_load_dwordx4 v18, s[28:31], s86 offen lds
  s_add_u32 m0, s92, 25600
  s_add_u32 s86, s3, 0
  buffer_load_dwordx4 v19, s[28:31], s86 offen lds
  s_add_u32 s3, s95, 4
  s_cmp_ge_u32 s3, 22
  s_cselect_b32 s78, 22, 0
  s_sub_u32 s3, s3, s78
  s_lshl_b32 s3, s3, 16
  s_add_u32 m0, s92, 32768
  s_add_u32 s86, s3, 0
  buffer_load_dwordx4 v18, s[28:31], s86 offen lds
  s_add_u32 m0, s92, 33792
  s_add_u32 s86, s3, 0
  buffer_load_dwordx4 v19, s[28:31], s86 offen lds
  s_add_u32 s3, s95, 5
  s_cmp_ge_u32 s3, 22
  s_cselect_b32 s78, 22, 0
  s_sub_u32 s3, s3, s78
  s_lshl_b32 s3, s3, 16
  s_add_u32 m0, s92, 40960
  s_add_u32 s86, s3, 0
  buffer_load_dwordx4 v18, s[28:31], s86 offen lds
  s_add_u32 m0, s92, 41984
  s_add_u32 s86, s3, 0
  buffer_load_dwordx4 v19, s[28:31], s86 offen lds
  s_add_u32 s3, s95, 6
  s_cmp_ge_u32 s3, 22
  s_cselect_b32 s78, 22, 0
  s_sub_u32 s3, s3, s78
  s_lshl_b32 s3, s3, 16
  s_add_u32 m0, s92, 49152
  s_add_u32 s86, s3, 0
  buffer_load_dwordx4 v18, s[28:31], s86 offen lds
  s_add_u32 m0, s92, 50176
  s_add_u32 s86, s3, 0
  buffer_load_dwordx4 v19, s[28:31], s86 offen lds
  s_add_u32 s3, s95, 7
  s_cmp_ge_u32 s3, 22
  s_cselect_b32 s78, 22, 0
  s_sub_u32 s3, s3, s78
  s_lshl_b32 s3, s3, 16
  s_add_u32 m0, s92, 57344
  s_add_u32 s86, s3, 0
  buffer_load_dwordx4 v18, s[28:31], s86 offen lds
  s_add_u32 m0, s92, 58368
  s_add_u32 s86, s3, 0
  buffer_load_dwordx4 v19, s[28:31], s86 offen lds
  s_add_u32 s3, s95, 8
  s_cmp_ge_u32 s3, 22
  s_cselect_b32 s78, 22, 0
  s_sub_u32 s3, s3, s78
  s_lshl_b32 s3, s3, 16
  s_add_u32 m0, s92, 98304
  s_add_u32 s86, s3, 0
  buffer_load_dwordx4 v18, s[28:31], s86 offen lds
  s_add_u32 m0, s92, 99328
  s_add_u32 s86, s3, 0
  buffer_load_dwordx4 v19, s[28:31], s86 offen lds
  s_add_u32 s3, s95, 9
  s_cmp_ge_u32 s3, 22
  s_cselect_b32 s78, 22, 0
  s_sub_u32 s3, s3, s78
  s_lshl_b32 s3, s3, 16
  s_add_u32 m0, s92, 106496
  s_add_u32 s86, s3, 0
  buffer_load_dwordx4 v18, s[28:31], s86 offen lds
  s_add_u32 m0, s92, 107520
  s_add_u32 s86, s3, 0
  buffer_load_dwordx4 v19, s[28:31], s86 offen lds
  s_add_u32 s3, s95, 10
  s_cmp_ge_u32 s3, 22
  s_cselect_b32 s78, 22, 0
  s_sub_u32 s3, s3, s78
  s_lshl_b32 s3, s3, 16
  s_add_u32 m0, s92, 114688
  s_add_u32 s86, s3, 0
  buffer_load_dwordx4 v18, s[28:31], s86 offen lds
  s_add_u32 m0, s92, 115712
  s_add_u32 s86, s3, 0
  buffer_load_dwordx4 v19, s[28:31], s86 offen lds
  s_add_u32 s3, s95, 11
  s_cmp_ge_u32 s3, 22
  s_cselect_b32 s78, 22, 0
  s_sub_u32 s3, s3, s78
  s_lshl_b32 s3, s3, 16
  s_add_u32 m0, s92, 122880
  s_add_u32 s86, s3, 0
  buffer_load_dwordx4 v18, s[28:31], s86 offen lds
  s_add_u32 m0, s92, 123904
  s_add_u32 s86, s3, 0
  buffer_load_dwordx4 v19, s[28:31], s86 offen lds
  s_barrier
  s_add_u32 s3, s95, 12
  s_cmp_ge_u32 s3, 22
  s_cselect_b32 s78, 22, 0
  s_sub_u32 s3, s3, s78
  s_lshl_b32 s3, s3, 16
  s_add_u32 m0, s92, 65536
  s_add_u32 s86, s3, 0
  buffer_load_dwordx4 v18, s[28:31], s86 offen lds
  s_add_u32 m0, s92, 66560
  s_add_u32 s86, s3, 0
  buffer_load_dwordx4 v19, s[28:31], s86 offen lds
  s_add_u32 s3, s95, 13
  s_cmp_ge_u32 s3, 22
  s_cselect_b32 s78, 22, 0
  s_sub_u32 s3, s3, s78
  s_lshl_b32 s3, s3, 16
  s_add_u32 m0, s92, 73728
  s_add_u32 s86, s3, 0
  buffer_load_dwordx4 v18, s[28:31], s86 offen lds
  s_add_u32 m0, s92, 74752
  s_add_u32 s86, s3, 0
  buffer_load_dwordx4 v19, s[28:31], s86 offen lds
  s_barrier
  s_add_u32 s3, s95, 0
  s_cmp_ge_u32 s3, 22
  s_cselect_b32 s78, 22, 0
  s_sub_u32 s3, s3, s78
  s_lshl_b32 s3, s3, 7
  s_add_u32 s3, s3, s64
  s_add_u32 m0, s92, 81920
  s_add_u32 s86, s3, 0
  buffer_load_dwordx4 v38, s[36:39], s86 offen sc1 lds
  s_add_u32 m0, s92, 82944
  s_add_u32 s86, s3, 0
  buffer_load_dwordx4 v39, s[36:39], s86 offen sc1 lds
  s_add_u32 s3, s95, 1
  s_cmp_ge_u32 s3, 22
  s_cselect_b32 s78, 22, 0
  s_sub_u32 s3, s3, s78
  s_lshl_b32 s3, s3, 7
  s_add_u32 s3, s3, s64
  s_add_u32 m0, s92, 90112
  s_add_u32 s86, s3, 0
  buffer_load_dwordx4 v38, s[36:39], s86 offen sc1 lds
  s_add_u32 m0, s92, 91136
  s_add_u32 s86, s3, 0
  buffer_load_dwordx4 v39, s[36:39], s86 offen sc1 lds
  s_add_u32 s3, s95, 2
  s_cmp_ge_u32 s3, 22
  s_cselect_b32 s78, 22, 0
  s_sub_u32 s3, s3, s78
  s_lshl_b32 s3, s3, 7
  s_add_u32 s3, s3, s64
  s_add_u32 m0, s92, 131072
  s_add_u32 s86, s3, 0
  buffer_load_dwordx4 v38, s[36:39], s86 offen sc1 lds
  s_add_u32 m0, s92, 132096
  s_add_u32 s86, s3, 0
  buffer_load_dwordx4 v39, s[36:39], s86 offen sc1 lds
  s_add_u32 s3, s95, 3
  s_cmp_ge_u32 s3, 22
  s_cselect_b32 s78, 22, 0
  s_sub_u32 s3, s3, s78
  s_lshl_b32 s3, s3, 7
  s_add_u32 s3, s3, s64
  s_add_u32 m0, s92, 139264
  s_add_u32 s86, s3, 0
  buffer_load_dwordx4 v38, s[36:39], s86 offen sc1 lds
  s_add_u32 m0, s92, 140288
  s_add_u32 s86, s3, 0
  buffer_load_dwordx4 v39, s[36:39], s86 offen sc1 lds
  s_waitcnt vmcnt(6)
  s_waitcnt vmcnt(4)
  s_barrier
  s_add_u32 s3, s95, 4
  s_cmp_ge_u32 s3, 22
  s_cselect_b32 s78, 22, 0
  s_sub_u32 s3, s3, s78
  s_lshl_b32 s3, s3, 7
  s_add_u32 s3, s3, s64
  s_add_u32 m0, s92, 147456
  s_add_u32 s86, s3, 0
  buffer_load_dwordx4 v38, s[36:39], s86 offen sc1 lds
  s_add_u32 m0, s92, 148480
  s_add_u32 s86, s3, 0
  buffer_load_dwordx4 v39, s[36:39], s86 offen sc1 lds
  s_add_u32 s3, s95, 5
  s_cmp_ge_u32 s3, 22
  s_cselect_b32 s78, 22, 0
  s_sub_u32 s3, s3, s78
  s_lshl_b32 s3, s3, 7
  s_add_u32 s3, s3, s64
  s_add_u32 m0, s92, 155648
  s_add_u32 s86, s3, 0
  buffer_load_dwordx4 v38, s[36:39], s86 offen sc1 lds
  s_add_u32 m0, s92, 156672
  s_add_u32 s86, s3, 0
  buffer_load_dwordx4 v39, s[36:39], s86 offen sc1 lds
  s_waitcnt vmcnt(6)
  s_waitcnt vmcnt(4)
  s_barrier
  s_add_u32 s3, s95, 6
  s_cmp_ge_u32 s3, 22
  s_cselect_b32 s78, 22, 0
  s_sub_u32 s3, s3, s78
  s_lshl_b32 s3, s3, 7
  s_add_u32 s3, s3, s64
  s_add_u32 m0, s92, 81920
  s_add_u32 s86, s3, 0
  buffer_load_dwordx4 v38, s[36:39], s86 offen sc1 lds
  s_add_u32 m0, s92, 82944
  s_add_u32 s86, s3, 0
  buffer_load_dwordx4 v39, s[36:39], s86 offen sc1 lds
  s_add_u32 s3, s95, 7
  s_cmp_ge_u32 s3, 22
  s_cselect_b32 s78, 22, 0
  s_sub_u32 s3, s3, s78
  s_lshl_b32 s3, s3, 7
  s_add_u32 s3, s3, s64
  s_add_u32 m0, s92, 0
  s_add_u32 s86, s3, 0
  buffer_load_dwordx4 v38, s[36:39], s86 offen sc1 lds
  s_add_u32 m0, s92, 1024
  s_add_u32 s86, s3, 0
  buffer_load_dwordx4 v39, s[36:39], s86 offen sc1 lds
  s_add_u32 s3, s95, 8
  s_cmp_ge_u32 s3, 22
  s_cselect_b32 s78, 22, 0
  s_sub_u32 s3, s3, s78
  s_lshl_b32 s3, s3, 7
  s_add_u32 s3, s3, s64
  s_add_u32 m0, s92, 90112
  s_add_u32 s86, s3, 0
  buffer_load_dwordx4 v38, s[36:39], s86 offen sc1 lds
  s_add_u32 m0, s92, 91136
  s_add_u32 s86, s3, 0
  buffer_load_dwordx4 v39, s[36:39], s86 offen sc1 lds
  s_add_u32 s3, s95, 9
  s_cmp_ge_u32 s3, 22
  s_cselect_b32 s78, 22, 0
  s_sub_u32 s3, s3, s78
  s_lshl_b32 s3, s3, 7
  s_add_u32 s3, s3, s64
  s_add_u32 m0, s92, 8192
  s_add_u32 s86, s3, 0
  buffer_load_dwordx4 v38, s[36:39], s86 offen sc1 lds
  s_add_u32 m0, s92, 9216
  s_add_u32 s86, s3, 0
  buffer_load_dwordx4 v39, s[36:39], s86 offen sc1 lds
  s_waitcnt vmcnt(10)
  s_waitcnt vmcnt(8)
  s_barrier
  s_add_u32 s3, s95, 10
  s_cmp_ge_u32 s3, 22
  s_cselect_b32 s78, 22, 0
  s_sub_u32 s3, s3, s78
  s_lshl_b32 s3, s3, 7
  s_add_u32 s3, s3, s64
  s_add_u32 m0, s92, 131072
  s_add_u32 s86, s3, 0
  buffer_load_dwordx4 v38, s[36:39], s86 offen sc1 lds
  s_add_u32 m0, s92, 132096
  s_add_u32 s86, s3, 0
  buffer_load_dwordx4 v39, s[36:39], s86 offen sc1 lds
  s_add_u32 s3, s95, 11
  s_cmp_ge_u32 s3, 22
  s_cselect_b32 s78, 22, 0
  s_sub_u32 s3, s3, s78
  s_lshl_b32 s3, s3, 7
  s_add_u32 s3, s3, s64
  s_add_u32 m0, s92, 16384
  s_add_u32 s86, s3, 0
  buffer_load_dwordx4 v38, s[36:39], s86 offen sc1 lds
  s_add_u32 m0, s92, 17408
  s_add_u32 s86, s3, 0
  buffer_load_dwordx4 v39, s[36:39], s86 offen sc1 lds
  s_waitcnt vmcnt(10)
  s_waitcnt vmcnt(8)
  s_barrier
  s_add_u32 s3, s95, 12
  s_cmp_ge_u32 s3, 22
  s_cselect_b32 s78, 22, 0
  s_sub_u32 s3, s3, s78
  s_lshl_b32 s3, s3, 7
  s_add_u32 s3, s3, s64
  s_add_u32 m0, s92, 139264
  s_add_u32 s86, s3, 0
  buffer_load_dwordx4 v38, s[36:39], s86 offen sc1 lds
  s_add_u32 m0, s92, 140288
  s_add_u32 s86, s3, 0
  buffer_load_dwordx4 v39, s[36:39], s86 offen sc1 lds
  s_add_u32 s3, s95, 13
  s_cmp_ge_u32 s3, 22
  s_cselect_b32 s78, 22, 0
  s_sub_u32 s3, s3, s78
  s_lshl_b32 s3, s3, 7
  s_add_u32 s3, s3, s64
  s_add_u32 m0, s92, 24576
  s_add_u32 s86, s3, 0
  buffer_load_dwordx4 v38, s[36:39], s86 offen sc1 lds
  s_add_u32 m0, s92, 25600
  s_add_u32 s86, s3, 0
  buffer_load_dwordx4 v39, s[36:39], s86 offen sc1 lds
  s_waitcnt vmcnt(10)
  s_waitcnt vmcnt(8)
  s_barrier
  s_add_u32 s3, s95, 14
  s_cmp_ge_u32 s3, 22
  s_cselect_b32 s78, 22, 0
  s_sub_u32 s3, s3, s78
  s_lshl_b32 s3, s3, 7
  s_add_u32 s3, s3, s64
  s_add_u32 m0, s92, 147456
  s_add_u32 s86, s3, 0
  buffer_load_dwordx4 v38, s[36:39], s86 offen sc1 lds
  s_add_u32 m0, s92, 148480
  s_add_u32 s86, s3, 0
  buffer_load_dwordx4 v39, s[36:39], s86 offen sc1 lds
  s_add_u32 s3, s95, 14
  s_cmp_ge_u32 s3, 22
  s_cselect_b32 s78, 22, 0
  s_sub_u32 s3, s3, s78
  s_lshl_b32 s3, s3, 16
  s_add_u32 m0, s92, 32768
  s_add_u32 s86, s3, 0
  buffer_load_dwordx4 v18, s[28:31], s86 offen lds
  s_add_u32 m0, s92, 33792
  s_add_u32 s86, s3, 0
  buffer_load_dwordx4 v19, s[28:31], s86 offen lds
  s_add_u32 s3, s95, 15
  s_cmp_ge_u32 s3, 22
  s_cselect_b32 s78, 22, 0
  s_sub_u32 s3, s3, s78
  s_lshl_b32 s3, s3, 7
  s_add_u32 s3, s3, s64
  s_add_u32 m0, s92, 155648
  s_add_u32 s86, s3, 0
  buffer_load_dwordx4 v38, s[36:39], s86 offen sc1 lds
  s_add_u32 m0, s92, 156672
  s_add_u32 s86, s3, 0
  buffer_load_dwordx4 v39, s[36:39], s86 offen sc1 lds
  s_add_u32 s3, s95, 15
  s_cmp_ge_u32 s3, 22
  s_cselect_b32 s78, 22, 0
  s_sub_u32 s3, s3, s78
  s_lshl_b32 s3, s3, 16
  s_add_u32 m0, s92, 40960
  s_add_u32 s86, s3, 0
  buffer_load_dwordx4 v18, s[28:31], s86 offen lds
  s_add_u32 m0, s92, 41984
  s_add_u32 s86, s3, 0
  buffer_load_dwordx4 v19, s[28:31], s86 offen lds
  s_waitcnt vmcnt(14)
  s_waitcnt vmcnt(12)
  s_barrier
  s_add_u32 s3, s95, 16
  s_cmp_ge_u32 s3, 22
  s_cselect_b32 s78, 22, 0
  s_sub_u32 s3, s3, s78
  s_lshl_b32 s3, s3, 7
  s_add_u32 s3, s3, s64
  s_add_u32 m0, s92, 81920
  s_add_u32 s86, s3, 0
  buffer_load_dwordx4 v38, s[36:39], s86 offen sc1 lds
  s_add_u32 m0, s92, 82944
  s_add_u32 s86, s3, 0
  buffer_load_dwordx4 v39, s[36:39], s86 offen sc1 lds
  s_add_u32 s3, s95, 16
  s_cmp_ge_u32 s3, 22
  s_cselect_b32 s78, 22, 0
  s_sub_u32 s3, s3, s78
  s_lshl_b32 s3, s3, 16
  s_add_u32 m0, s92, 49152
  s_add_u32 s86, s3, 0
  buffer_load_dwordx4 v18, s[28:31], s86 offen lds
  s_add_u32 m0, s92, 50176
  s_add_u32 s86, s3, 0
  buffer_load_dwordx4 v19, s[28:31], s86 offen lds
  s_add_u32 s3, s95, 17
  s_cmp_ge_u32 s3, 22
  s_cselect_b32 s78, 22, 0
  s_sub_u32 s3, s3, s78
  s_lshl_b32 s3, s3, 7
  s_add_u32 s3, s3, s64
  s_add_u32 m0, s92, 0
  s_add_u32 s86, s3, 0
  buffer_load_dwordx4 v38, s[36:39], s86 offen sc1 lds
  s_add_u32 m0, s92, 1024
  s_add_u32 s86, s3, 0
  buffer_load_dwordx4 v39, s[36:39], s86 offen sc1 lds
  s_add_u32 s3, s95, 17
  s_cmp_ge_u32 s3, 22
  s_cselect_b32 s78, 22, 0
  s_sub_u32 s3, s3, s78
  s_lshl_b32 s3, s3, 16
  s_add_u32 m0, s92, 57344
  s_add_u32 s86, s3, 0
  buffer_load_dwordx4 v18, s[28:31], s86 offen lds
  s_add_u32 m0, s92, 58368
  s_add_u32 s86, s3, 0
  buffer_load_dwordx4 v19, s[28:31], s86 offen lds
  s_waitcnt vmcnt(18)
  s_waitcnt vmcnt(16)
  s_barrier
  s_add_u32 s3, s95, 18
  s_cmp_ge_u32 s3, 22
  s_cselect_b32 s78, 22, 0
  s_sub_u32 s3, s3, s78
  s_lshl_b32 s3, s3, 7
  s_add_u32 s3, s3, s64
  s_add_u32 m0, s92, 90112
  s_add_u32 s86, s3, 0
  buffer_load_dwordx4 v38, s[36:39], s86 offen sc1 lds
  s_add_u32 m0, s92, 91136
  s_add_u32 s86, s3, 0
  buffer_load_dwordx4 v39, s[36:39], s86 offen sc1 lds
  s_add_u32 s3, s95, 18
  s_cmp_ge_u32 s3, 22
  s_cselect_b32 s78, 22, 0
  s_sub_u32 s3, s3, s78
  s_lshl_b32 s3, s3, 16
  s_add_u32 m0, s92, 98304
  s_add_u32 s86, s3, 0
  buffer_load_dwordx4 v18, s[28:31], s86 offen lds
  s_add_u32 m0, s92, 99328
  s_add_u32 s86, s3, 0
  buffer_load_dwordx4 v19, s[28:31], s86 offen lds
  s_add_u32 s3, s95, 19
  s_cmp_ge_u32 s3, 22
  s_cselect_b32 s78, 22, 0
  s_sub_u32 s3, s3, s78
  s_lshl_b32 s3, s3, 7
  s_add_u32 s3, s3, s64
  s_add_u32 m0, s92, 8192
  s_add_u32 s86, s3, 0
  buffer_load_dwordx4 v38, s[36:39], s86 offen sc1 lds
  s_add_u32 m0, s92, 9216
  s_add_u32 s86, s3, 0
  buffer_load_dwordx4 v39, s[36:39], s86 offen sc1 lds
  s_add_u32 s3, s95, 19
  s_cmp_ge_u32 s3, 22
  s_cselect_b32 s78, 22, 0
  s_sub_u32 s3, s3, s78
  s_lshl_b32 s3, s3, 16
  s_add_u32 m0, s92, 106496
  s_add_u32 s86, s3, 0
  buffer_load_dwordx4 v18, s[28:31], s86 offen lds
  s_add_u32 m0, s92, 107520
  s_add_u32 s86, s3, 0
  buffer_load_dwordx4 v19, s[28:31], s86 offen lds
  s_waitcnt vmcnt(22)
  s_waitcnt vmcnt(20)
  s_waitcnt vmcnt(18)
  s_waitcnt vmcnt(16)
  s_barrier
  s_add_u32 s3, s95, 20
  s_cmp_ge_u32 s3, 22
  s_cselect_b32 s78, 22, 0
  s_sub_u32 s3, s3, s78
  s_lshl_b32 s3, s3, 7
  s_add_u32 s3, s3, s64
  s_add_u32 m0, s92, 131072
  s_add_u32 s86, s3, 0
  buffer_load_dwordx4 v38, s[36:39], s86 offen sc1 lds
  s_add_u32 m0, s92, 132096
  s_add_u32 s86, s3, 0
  buffer_load_dwordx4 v39, s[36:39], s86 offen sc1 lds
  s_add_u32 s3, s95, 20
  s_cmp_ge_u32 s3, 22
  s_cselect_b32 s78, 22, 0
  s_sub_u32 s3, s3, s78
  s_lshl_b32 s3, s3, 16
  s_add_u32 m0, s92, 114688
  s_add_u32 s86, s3, 0
  buffer_load_dwordx4 v18, s[28:31], s86 offen lds
  s_add_u32 m0, s92, 115712
  s_add_u32 s86, s3, 0
  buffer_load_dwordx4 v19, s[28:31], s86 offen lds
  s_add_u32 s3, s95, 21
  s_cmp_ge_u32 s3, 22
  s_cselect_b32 s78, 22, 0
  s_sub_u32 s3, s3, s78
  s_lshl_b32 s3, s3, 7
  s_add_u32 s3, s3, s64
  s_add_u32 m0, s92, 16384
  s_add_u32 s86, s3, 0
  buffer_load_dwordx4 v38, s[36:39], s86 offen sc1 lds
  s_add_u32 m0, s92, 17408
  s_add_u32 s86, s3, 0
  buffer_load_dwordx4 v39, s[36:39], s86 offen sc1 lds
  s_add_u32 s3, s95, 21
  s_cmp_ge_u32 s3, 22
  s_cselect_b32 s78, 22, 0
  s_sub_u32 s3, s3, s78
  s_lshl_b32 s3, s3, 16
  s_add_u32 m0, s92, 122880
  s_add_u32 s86, s3, 0
  buffer_load_dwordx4 v18, s[28:31], s86 offen lds
  s_add_u32 m0, s92, 123904
  s_add_u32 s86, s3, 0
  buffer_load_dwordx4 v19, s[28:31], s86 offen lds
  s_waitcnt vmcnt(22)
  s_waitcnt vmcnt(20)
  s_waitcnt vmcnt(18)
  s_waitcnt vmcnt(16)
  s_barrier
  s_waitcnt vmcnt(14)
  s_waitcnt vmcnt(12)
  s_waitcnt vmcnt(10)
  s_waitcnt vmcnt(8)
  s_barrier
  s_waitcnt vmcnt(6)
  s_waitcnt vmcnt(4)
  s_waitcnt vmcnt(2)
  s_waitcnt vmcnt(0)
  s_barrier
  s_endpgm
L_CODE_END:
.section .rodata,"a"
.p2align 6
.amdhsa_kernel parallel_sum__sliding_local_dilated__mixer_s_mlp__prompt_kernel
  .amdhsa_next_free_vgpr 256
  .amdhsa_next_free_sgpr 100
  .amdhsa_accum_offset 256
  .amdhsa_group_segment_fixed_size 0
  .amdhsa_kernarg_size 88
  .amdhsa_user_sgpr_count 2
  .amdhsa_user_sgpr_kernarg_segment_ptr 1
  .amdhsa_system_sgpr_workgroup_id_x 1
.end_amdhsa_kernel
```
